```python
import torch

def _softmax(x, axis=-1):
    return torch.softmax(x, dim=axis)

def _gelu(x):
    return torch.nn.functional.gelu(x, approximate='tanh')

def _silu(x):
    return torch.nn.functional.silu(x)

def _sigmoid(x):
    return torch.sigmoid(x)

def _layernorm(x, axis=-1, eps=1e-05):
    m = x.mean(dim=axis, keepdim=True)
    v = x.var(dim=axis, keepdim=True, unbiased=False)
    return (x - m) / torch.sqrt(v + eps)

def _scatter_add(tgt, idx, src, axis=0):
    return tgt.clone().index_add_(axis, idx, src)

def _segment_sum(src, seg, n):
    out = torch.zeros((n,) + src.shape[1:], dtype=src.dtype)
    return out.index_add_(0, seg, src)

def _pad(x, pw):
    flat = tuple((v for pair in reversed(pw) for v in pair))
    return torch.nn.functional.pad(x, flat)
kernel_name = 'adaLN_cond__gqa_block_cached__swiglu_ffn__decode'

def setup_inputs():

    _w = lambda a: (lambda t: t.to(torch.bfloat16) if t.is_floating_point() else t)(torch.as_tensor(a))

    def _A_setup():
        B, Sq, D = (1, 1, 512)
        Hq, Hkv, Sk, Dh = (32, 32, 8192, 128)
        assert Hq % Hkv == 0, (Hq, Hkv)
        return {'x': _w((lambda *s: torch.randn(*s, dtype=torch.bfloat16) * 0.05)(B, Sq, D)), 'k_cache': _w((lambda *s: torch.randn(*s, dtype=torch.bfloat16) * 3.2)(B, Hkv, Sk, Dh)), 'v_cache': _w((lambda *s: torch.randn(*s, dtype=torch.bfloat16) * 0.4)(B, Hkv, Sk, Dh)), 'wq': _w((lambda *s: torch.randn(*s, dtype=torch.bfloat16) * 3.2)(D, Hq * Dh) * D ** (-0.5)), 'wo': _w((lambda *s: torch.randn(*s, dtype=torch.bfloat16) * 0.4)(Hq * Dh, D) * (Hq * Dh) ** (-0.5))}
    _A_in = _A_setup()

    def _B_setup():
        B, S, D, F = (1, 1, 512, 1376)
        return {'x': _w((lambda *s: torch.randn(*s, dtype=torch.bfloat16) * 0.05)(B, S, D)), 'w_gate': _w((lambda *s: torch.randn(*s, dtype=torch.bfloat16) * 0.05)(D, F)), 'w_up': _w((lambda *s: torch.randn(*s, dtype=torch.bfloat16) * 0.05)(D, F)), 'w_down': _w((lambda *s: torch.randn(*s, dtype=torch.bfloat16) * 0.05)(F, D))}
    _B_in = _B_setup()
    return {'A_x': _A_in['x'], 'A_k_cache': _A_in['k_cache'], 'A_v_cache': _A_in['v_cache'], 'A_wq': _A_in['wq'], 'A_wo': _A_in['wo'], 'B_x': _B_in['x'], 'B_w_gate': _B_in['w_gate'], 'B_w_up': _B_in['w_up'], 'B_w_down': _B_in['w_down'], 'c': _w((lambda *s: torch.randn(*s, dtype=torch.bfloat16) * 0.1)(1, 512) * 8.0), 'w_mod': _w((lambda *s: torch.randn(*s, dtype=torch.bfloat16) * 0.1)(512, 6 * 512) * 512 ** (-0.5) * 8.0)}

def reference(A_x, A_k_cache, A_v_cache, A_wq, A_wo, B_x, B_w_gate, B_w_up, B_w_down, c, w_mod):

    def _A_ref(x, k_cache, v_cache, wq, wo):
        B, Sq, D = x.shape
        Hq, Dh = (32, 128)
        Hkv = k_cache.shape[1]
        rep = Hq // Hkv
        q = (lambda x, *d: x.permute(*d))((x @ wq).reshape(B, Sq, Hq, Dh), 0, 2, 1, 3)
        k = (lambda x, n, axis: torch.repeat_interleave(x, n, dim=axis))(k_cache, rep, axis=1)
        v = (lambda x, n, axis: torch.repeat_interleave(x, n, dim=axis))(v_cache, rep, axis=1)
        scores = torch.einsum('bhqd,bhkd->bhqk', q, k) * Dh ** (-0.5)
        p = _softmax(scores, axis=-1)
        o = torch.einsum('bhqk,bhkd->bhqd', p, v)
        return (lambda x, *d: x.permute(*d))(o, 0, 2, 1, 3).reshape(B, Sq, Hq * Dh) @ wo

    def _B_ref(x, w_gate, w_up, w_down):
        g = _silu(x @ w_gate)
        u = x @ w_up
        return g * u @ w_down
    x = A_x
    mod = (_silu(c) @ w_mod).reshape(c.shape[0], 6, 1, -1)
    sa, ca, ga, sb, cb, gb = (mod[:, 0].clone(), mod[:, 1].clone(), mod[:, 2].clone(), mod[:, 3].clone(), mod[:, 4].clone(), mod[:, 5].clone())
    h = _layernorm(x, axis=-1) * (1 + ca) + sa
    x = x + ga * _A_ref(h, A_k_cache, A_v_cache, A_wq, A_wo)
    h = _layernorm(x, axis=-1) * (1 + cb) + sb
    x = x + gb * _B_ref(h, B_w_gate, B_w_up, B_w_down)
    return x
```

```asm
; @launch grid=(256,1,1) block=(512,1,1) lds=16384
.amdgcn_target "amdgcn-amd-amdhsa--gfx950"
.text
.globl adaLN_cond__gqa_block_cached__swiglu_ffn__decode_kernel
.p2align 8
.type adaLN_cond__gqa_block_cached__swiglu_ffn__decode_kernel,@function
adaLN_cond__gqa_block_cached__swiglu_ffn__decode_kernel:
  s_cmp_ge_u32 s2, 256
  s_cbranch_scc1 L_end
  s_load_dwordx16 s[52:67], s[0:1], 0
  s_load_dwordx8 s[68:75], s[0:1], 64
  s_load_dwordx2 s[76:77], s[0:1], 104
  v_lshlrev_b32 v1, 3, v0
  v_mov_b32 v2, 0
  v_mov_b32 v3, 0
  ds_write_b64 v1, v[2:3]
  v_lshrrev_b32 v1, 6, v0
  v_and_b32 v0, 63, v0
  v_readfirstlane_b32 s97, v1
  s_and_b32 s100, s2, 7
  s_lshr_b32 s101, s2, 3
  s_mov_b32 s78, 32768
  s_mov_b32 s79, 65536
  s_mov_b32 s80, 98304
  s_mov_b32 s81, 131072
  s_mov_b32 s82, 163840
  s_mov_b32 s83, 196608
  s_mov_b32 s84, 229376
  v_and_b32 v1, 1, v0
  v_lshlrev_b32 v1, 4, v1
  v_mov_b32 v2, 0xffff
  v_lshlrev_b32 v1, v1, v2
  v_bfe_u32 v2, v0, 1, 2
  v_cmp_eq_u32 vcc, 0, v2
  s_nop 1
  v_cndmask_b32 v4, 0, v1, vcc
  v_cmp_eq_u32 vcc, 1, v2
  s_nop 1
  v_cndmask_b32 v5, 0, v1, vcc
  v_cmp_eq_u32 vcc, 2, v2
  s_nop 1
  v_cndmask_b32 v6, 0, v1, vcc
  v_cmp_eq_u32 vcc, 3, v2
  s_nop 1
  v_cndmask_b32 v7, 0, v1, vcc
  v_lshrrev_b32 v3, 3, v0
  v_and_b32 v2, 7, v0
  v_lshlrev_b32 v2, 4, v2
  v_lshl_add_u32 v1, v3, 8, v2
  s_lshl_b32 s3, s100, 5
  s_add_u32 s3, s3, s101
  s_lshr_b32 s96, s3, 3
  s_lshl_b32 s3, s3, 18
  s_lshl_b32 vcc_lo, s97, 12
  s_add_u32 s3, s3, vcc_lo
  v_add_u32 v1, s3, v1
  v_lshl_add_u32 v2, v3, 13, v2
  s_and_b32 s3, s101, 7
  s_lshl_b32 s3, s3, 19
  s_lshl_b32 vcc_lo, s96, 8
  s_add_u32 s3, s3, vcc_lo
  s_lshl_b32 vcc_lo, s97, 16
  s_add_u32 s3, s3, vcc_lo
  v_add_u32 v2, s3, v2
  s_lshr_b32 s89, s100, 1
  s_lshl_b32 s89, s89, 4
  s_and_b32 s3, s101, 15
  s_add_u32 s89, s89, s3
  s_and_b32 s93, s100, 1
  s_xor_b32 s93, s93, 1
  s_lshr_b32 s90, s89, 5
  s_lshr_b32 s3, s89, 4
  s_add_u32 s3, s3, 2
  s_cmp_lt_u32 s101, 16
  s_cselect_b32 s90, s3, s90
  s_cselect_b32 s3, 1, 2
  s_lshr_b32 s92, s89, s3
  s_and_b32 s92, s92, 7
  s_and_b32 s91, s89, 3
  s_lshl_b32 s94, s91, 7
  s_and_b32 s3, s89, 1
  s_lshl_b32 vcc_lo, s3, 8
  s_lshl_b32 s3, s3, 1
  s_lshr_b32 vcc_hi, s89, 5
  s_add_u32 s3, s3, vcc_hi
  s_add_u32 s3, s3, 4
  s_cmp_lt_u32 s101, 16
  s_cselect_b32 s91, s3, s91
  s_cselect_b32 s94, vcc_lo, s94
  s_cselect_b32 s3, 5, 4
  s_lshl_b32 s3, s97, s3
  s_add_u32 s94, s94, s3
  v_lshrrev_b32 v3, 3, v0
  v_mul_u32_u24 v18, 12288, v3
  v_and_b32 v19, 7, v0
  v_lshl_add_u32 v18, v19, 4, v18
  s_mul_i32 s3, s94, 6144
  s_lshl_b32 vcc_lo, s90, 10
  s_add_u32 s3, s3, vcc_lo
  s_lshl_b32 vcc_lo, s92, 7
  s_add_u32 s3, s3, vcc_lo
  v_add_u32 v18, s3, v18
  s_cmp_lt_u32 s101, 16
  s_cselect_b32 s3, 98304, 0x40000000
  v_add_u32 v19, s3, v18
  s_lshl_b32 s3, s94, 1
  v_lshl_add_u32 v36, v3, 2, s3
  v_lshlrev_b32 v109, 4, v0
  s_and_b32 s3, s101, 7
  s_lshl_b32 s3, s3, 7
  s_lshl_b32 vcc_lo, s97, 4
  s_add_u32 s3, s3, vcc_lo
  v_lshrrev_b32 v3, 3, v0
  v_lshl_add_u32 v110, v3, 1, s3
  v_mov_b32 v108, 0
  s_mov_b32 s85, 128
  s_waitcnt lgkmcnt(0)
  s_barrier
  s_mov_b32 s44, s70
  s_and_b32 s45, s71, 0xffff
  s_mov_b32 s46, 1024
  s_mov_b32 s47, 0x20000
  s_mov_b32 s20, s72
  s_and_b32 s21, s73, 0xffff
  s_mov_b32 s22, 3145728
  s_mov_b32 s23, 0x20000
  s_mov_b32 s40, s52
  s_and_b32 s41, s53, 0xffff
  s_mov_b32 s42, 1024
  s_mov_b32 s43, 0x20000
  s_cmp_eq_u32 s93, 0
  s_cbranch_scc1 L_nowm
  buffer_load_dword v16, v36, s[44:47], 0 offen nt
  buffer_load_dword v17, v36, s[44:47], 0 offen offset:32 nt
  s_mov_b32 s3, 6144
  buffer_load_dwordx4 v[20:23], v18, s[20:23], 0 offen nt
  buffer_load_dwordx4 v[24:27], v18, s[20:23], s3 offen nt
  buffer_load_dwordx4 v[48:51], v19, s[20:23], 0 offen nt
  buffer_load_dwordx4 v[52:55], v19, s[20:23], s3 offen nt
  s_barrier
L_nowm:
  buffer_load_dwordx4 v[104:107], v109, s[40:43], 0 offen nt
  buffer_load_short_d16_hi v108, v110, s[40:43], 0 offen nt
  s_mov_b32 s12, s58
  s_and_b32 s13, s59, 0xffff
  s_mov_b32 s14, 4194304
  s_mov_b32 s15, 0x20000
  buffer_load_dwordx4 v[40:43], v2, s[12:15], 0 offen nt
  buffer_load_dwordx4 v[44:47], v2, s[12:15], s85 offen nt
  s_mov_b32 s4, s54
  s_and_b32 s5, s55, 0xffff
  s_mov_b32 s6, 67108864
  s_mov_b32 s7, 0x20000
  s_mov_b32 s24, s76
  s_and_b32 s25, s77, 0xffff
  s_mov_b32 s26, 268435456
  s_mov_b32 s27, 0x20000
  s_load_dword s99, s[76:77], 0
  buffer_load_dwordx4 v[128:131], v1, s[4:7], 0 offen offset:0 nt
  buffer_load_dwordx4 v[132:135], v1, s[4:7], 0 offen offset:128 nt
  buffer_load_dwordx4 v[136:139], v1, s[4:7], 0 offen offset:2048 nt
  buffer_load_dwordx4 v[140:143], v1, s[4:7], 0 offen offset:2176 nt
  buffer_load_dwordx4 v[144:147], v1, s[4:7], s78 offen offset:0 nt
  s_mov_b32 s8, s56
  s_and_b32 s9, s57, 0xffff
  s_mov_b32 s10, 67108864
  s_mov_b32 s11, 0x20000
  s_mov_b32 s16, s60
  s_and_b32 s17, s61, 0xffff
  s_mov_b32 s18, 4194304
  s_mov_b32 s19, 0x20000
  s_mov_b32 s28, s64
  s_and_b32 s29, s65, 0xffff
  s_mov_b32 s30, 1409024
  s_mov_b32 s31, 0x20000
  s_mov_b32 s32, s66
  s_and_b32 s33, s67, 0xffff
  s_mov_b32 s34, 1409024
  s_mov_b32 s35, 0x20000
  s_mov_b32 s36, s68
  s_and_b32 s37, s69, 0xffff
  s_mov_b32 s38, 1409024
  s_mov_b32 s39, 0x20000
  s_mov_b32 s48, s74
  s_and_b32 s49, s75, 0xffff
  s_mov_b32 s50, 1024
  s_mov_b32 s51, 0x20000
  s_mov_b32 s54, 0x05040100
  s_mov_b32 s55, 0x07060302
  s_waitcnt lgkmcnt(0)
  s_add_u32 s99, s99, 1
  s_mul_i32 s98, s99, 0x9E3779B1
  s_lshr_b32 s3, s100, 1
  s_mul_i32 s52, s3, 11
  s_add_u32 s52, s52, s101
  s_cmp_lt_u32 s101, 11
  s_cselect_b32 s52, s52, 255
  s_bitcmp0_b32 s100, 0
  s_cselect_b32 s52, s52, 255
  s_cmp_lt_u32 s52, 43
  s_cselect_b32 s52, s52, 255
  s_mov_b32 s52, 255
  s_mov_b32 s53, 0
  s_cmp_eq_u32 s93, 0
  s_cbranch_scc1 L_nopub
  s_waitcnt vmcnt(13)
  v_lshlrev_b32 v28, 16, v16
  v_and_b32 v29, 0xffff0000, v16
  v_lshlrev_b32 v30, 16, v17
  v_and_b32 v31, 0xffff0000, v17
  v_mul_f32 v32, 0xbfb8aa3b, v28
  v_mul_f32 v33, 0xbfb8aa3b, v29
  v_mul_f32 v34, 0xbfb8aa3b, v30
  v_mul_f32 v35, 0xbfb8aa3b, v31
  v_exp_f32 v32, v32
  v_exp_f32 v33, v33
  v_exp_f32 v34, v34
  v_exp_f32 v35, v35
  v_add_f32 v32, 1.0, v32
  v_add_f32 v33, 1.0, v33
  v_add_f32 v34, 1.0, v34
  v_add_f32 v35, 1.0, v35
  v_rcp_f32 v32, v32
  v_rcp_f32 v33, v33
  v_rcp_f32 v34, v34
  v_rcp_f32 v35, v35
  v_mul_f32 v28, v28, v32
  v_mul_f32 v29, v29, v33
  v_mul_f32 v30, v30, v34
  v_mul_f32 v31, v31, v35
  v_cvt_pk_bf16_f32 v16, v28, v29
  v_cvt_pk_bf16_f32 v17, v30, v31
  s_waitcnt vmcnt(11)
  v_perm_b32 v28, v24, v20, s54
  v_perm_b32 v29, v24, v20, s55
  v_perm_b32 v30, v25, v21, s54
  v_perm_b32 v31, v25, v21, s55
  v_perm_b32 v32, v26, v22, s54
  v_perm_b32 v33, v26, v22, s55
  v_perm_b32 v34, v27, v23, s54
  v_perm_b32 v35, v27, v23, s55
  v_dot2_f32_bf16 v8, v28, v16, 0
  v_dot2_f32_bf16 v9, v29, v16, 0
  v_dot2_f32_bf16 v10, v30, v16, 0
  v_dot2_f32_bf16 v11, v31, v16, 0
  v_dot2_f32_bf16 v12, v32, v16, 0
  v_dot2_f32_bf16 v13, v33, v16, 0
  v_dot2_f32_bf16 v14, v34, v16, 0
  v_dot2_f32_bf16 v15, v35, v16, 0
  s_waitcnt vmcnt(9)
  v_perm_b32 v28, v52, v48, s54
  v_perm_b32 v29, v52, v48, s55
  v_perm_b32 v30, v53, v49, s54
  v_perm_b32 v31, v53, v49, s55
  v_perm_b32 v32, v54, v50, s54
  v_perm_b32 v33, v54, v50, s55
  v_perm_b32 v34, v55, v51, s54
  v_perm_b32 v35, v55, v51, s55
  v_dot2_f32_bf16 v8, v28, v17, v8
  v_dot2_f32_bf16 v9, v29, v17, v9
  v_dot2_f32_bf16 v10, v30, v17, v10
  v_dot2_f32_bf16 v11, v31, v17, v11
  v_dot2_f32_bf16 v12, v32, v17, v12
  v_dot2_f32_bf16 v13, v33, v17, v13
  v_dot2_f32_bf16 v14, v34, v17, v14
  v_dot2_f32_bf16 v15, v35, v17, v15
  v_permlane32_swap_b32 v8, v12
  v_permlane32_swap_b32 v9, v13
  v_permlane32_swap_b32 v10, v14
  v_permlane32_swap_b32 v11, v15
  v_add_f32 v8, v8, v12
  v_add_f32 v9, v9, v13
  v_add_f32 v10, v10, v14
  v_add_f32 v11, v11, v15
  s_nop 0
  v_permlane16_swap_b32 v8, v10
  v_permlane16_swap_b32 v9, v11
  v_add_f32 v8, v8, v10
  v_add_f32 v9, v9, v11
  s_nop 0
  v_add_f32_dpp v8, v8, v8 row_ror:8 row_mask:0xf bank_mask:0xf
  s_nop 1
  v_add_f32_dpp v8, v9, v9 row_ror:8 row_mask:0xf bank_mask:0xc
  v_and_b32 v19, 7, v0
  v_lshlrev_b32 v19, 5, v19
  v_lshrrev_b32 v20, 3, v0
  v_lshl_add_u32 v19, v20, 2, v19
  v_mov_b32 v20, 0
  v_mov_b32 v21, 1
  ds_add_f32 v19, v8 offset:0
  s_mov_b32 exec_lo, 1
  s_mov_b32 exec_hi, 0
  ds_add_rtn_u32 v22, v20, v21 offset:256
  s_mov_b64 exec, -1
  s_waitcnt lgkmcnt(0)
  v_readfirstlane_b32 s3, v22
  s_cmp_lg_u32 s3, 7
  s_cbranch_scc1 L_nopub
  v_lshlrev_b32 v28, 2, v0
  ds_read_b32 v16, v28 offset:0
  s_lshl_b32 s3, s91, 13
  s_lshl_b32 s54, s92, 10
  s_add_u32 s3, s3, s54
  s_and_b32 s54, s90, 1
  s_lshl_b32 s54, s54, 3
  s_add_u32 s3, s3, s54
  s_add_u32 s3, s3, 458752
  v_lshlrev_b32 v28, 4, v0
  v_mov_b32 v17, s98
  s_waitcnt lgkmcnt(0)
  buffer_store_dwordx2 v[16:17], v28, s[24:27], s3 offen sc0 sc1
L_nopub:
  s_waitcnt vmcnt(4)
  buffer_load_dwordx4 v[148:151], v1, s[4:7], s78 offen offset:128 nt
  v_lshlrev_b32 v8, 16, v104
  v_and_b32 v9, 0xffff0000, v104
  v_lshlrev_b32 v10, 16, v105
  v_and_b32 v11, 0xffff0000, v105
  v_lshlrev_b32 v12, 16, v106
  v_and_b32 v13, 0xffff0000, v106
  v_lshlrev_b32 v14, 16, v107
  v_and_b32 v15, 0xffff0000, v107
  v_add_f32 v30, v8, v9
  v_mul_f32 v31, v8, v8
  v_fmac_f32 v31, v9, v9
  v_add_f32 v30, v30, v10
  v_fmac_f32 v31, v10, v10
  v_add_f32 v30, v30, v11
  v_fmac_f32 v31, v11, v11
  v_add_f32 v30, v30, v12
  v_fmac_f32 v31, v12, v12
  v_add_f32 v30, v30, v13
  v_fmac_f32 v31, v13, v13
  v_add_f32 v30, v30, v14
  v_fmac_f32 v31, v14, v14
  v_add_f32 v30, v30, v15
  v_fmac_f32 v31, v15, v15
  s_nop 0
  v_add_f32_dpp v30, v30, v30 row_ror:8 row_mask:0xf bank_mask:0xf
  v_add_f32_dpp v31, v31, v31 row_ror:8 row_mask:0xf bank_mask:0xf
  s_nop 0
  v_add_f32_dpp v30, v30, v30 row_ror:4 row_mask:0xf bank_mask:0xf
  v_add_f32_dpp v31, v31, v31 row_ror:4 row_mask:0xf bank_mask:0xf
  s_nop 0
  v_add_f32_dpp v30, v30, v30 row_ror:2 row_mask:0xf bank_mask:0xf
  v_add_f32_dpp v31, v31, v31 row_ror:2 row_mask:0xf bank_mask:0xf
  s_nop 0
  v_add_f32_dpp v30, v30, v30 row_ror:1 row_mask:0xf bank_mask:0xf
  v_add_f32_dpp v31, v31, v31 row_ror:1 row_mask:0xf bank_mask:0xf
  s_nop 0
  v_add_f32_dpp v30, v30, v30 row_bcast:15 row_mask:0xa bank_mask:0xf
  v_add_f32_dpp v31, v31, v31 row_bcast:15 row_mask:0xa bank_mask:0xf
  s_nop 0
  v_add_f32_dpp v30, v30, v30 row_bcast:31 row_mask:0xc bank_mask:0xf
  v_add_f32_dpp v31, v31, v31 row_bcast:31 row_mask:0xc bank_mask:0xf
  v_readlane_b32 s54, v30, 63
  v_readlane_b32 s55, v31, 63
  s_nop 0
  v_mov_b32 v30, s54
  v_mov_b32 v31, s55
  v_mul_f32 v30, 0x3b000000, v30
  v_mul_f32 v31, 0x3b000000, v31
  v_fma_f32 v31, -v30, v30, v31
  v_cvt_pk_bf16_f32 v34, v30, v31
  v_lshlrev_b32 v30, 16, v34
  v_and_b32 v31, 0xffff0000, v34
  v_add_f32 v31, 0x3727c5ac, v31
  v_cvt_pk_bf16_f32 v31, v31, v31
  v_and_b32 v31, 0xffff0000, v31
  v_sqrt_f32 v31, v31
  s_nop 0
  v_cvt_pk_bf16_f32 v31, v31, v31
  v_and_b32 v31, 0xffff0000, v31
  v_rcp_f32 v31, v31
  s_waitcnt vmcnt(4)
  buffer_load_dwordx4 v[152:155], v1, s[4:7], s78 offen offset:2048 nt
  s_waitcnt vmcnt(4)
  buffer_load_dwordx4 v[156:159], v1, s[4:7], s78 offen offset:2176 nt
  s_waitcnt vmcnt(4)
  buffer_load_dwordx4 v[160:163], v1, s[4:7], s79 offen offset:0 nt
  s_waitcnt vmcnt(4)
  buffer_load_dwordx4 v[164:167], v1, s[4:7], s79 offen offset:128 nt
  s_waitcnt vmcnt(4)
  buffer_load_dwordx4 v[168:171], v1, s[4:7], s79 offen offset:2048 nt
  s_waitcnt vmcnt(4)
  buffer_load_dwordx4 v[172:175], v1, s[4:7], s79 offen offset:2176 nt
  s_waitcnt vmcnt(4)
  buffer_load_dwordx4 v[176:179], v1, s[4:7], s80 offen offset:0 nt
  s_waitcnt vmcnt(4)
  buffer_load_dwordx4 v[180:183], v1, s[4:7], s80 offen offset:128 nt
  s_waitcnt vmcnt(4)
  buffer_load_dwordx4 v[184:187], v1, s[4:7], s80 offen offset:2048 nt
  s_waitcnt vmcnt(4)
  buffer_load_dwordx4 v[188:191], v1, s[4:7], s80 offen offset:2176 nt
  s_waitcnt vmcnt(4)
  buffer_load_dwordx4 v[192:195], v1, s[4:7], s81 offen offset:0 nt
  s_waitcnt vmcnt(4)
  buffer_load_dwordx4 v[196:199], v1, s[4:7], s81 offen offset:128 nt
  s_waitcnt vmcnt(4)
  buffer_load_dwordx4 v[200:203], v1, s[4:7], s81 offen offset:2048 nt
  s_waitcnt vmcnt(4)
  buffer_load_dwordx4 v[204:207], v1, s[4:7], s81 offen offset:2176 nt
  s_waitcnt vmcnt(4)
  buffer_load_dwordx4 v[208:211], v1, s[4:7], s82 offen offset:0 nt
  s_waitcnt vmcnt(4)
  buffer_load_dwordx4 v[212:215], v1, s[4:7], s82 offen offset:128 nt
  s_waitcnt vmcnt(4)
  buffer_load_dwordx4 v[216:219], v1, s[4:7], s82 offen offset:2048 nt
  s_waitcnt vmcnt(4)
  buffer_load_dwordx4 v[220:223], v1, s[4:7], s82 offen offset:2176 nt
  s_and_b32 s55, s101, 7
  s_lshl_b32 s86, s55, 10
  s_lshl_b32 s55, s97, 7
  s_add_u32 s86, s86, s55
  s_add_u32 s86, s86, 458752
  s_add_u32 s87, s86, 8192
  s_add_u32 s88, s86, 16384
  s_add_u32 s94, s86, 24576
  v_lshrrev_b32 v29, 3, v0
  v_lshlrev_b32 v29, 4, v29
  buffer_load_dwordx4 v[112:115], v29, s[24:27], s86 offen sc1
  buffer_load_dwordx4 v[116:119], v29, s[24:27], s87 offen sc1
  buffer_load_dwordx4 v[120:123], v29, s[24:27], s88 offen sc1
  buffer_load_dwordx4 v[124:127], v29, s[24:27], s94 offen sc1
  s_waitcnt vmcnt(8)
  buffer_load_dwordx4 v[224:227], v1, s[4:7], s83 offen offset:0 nt
  s_waitcnt vmcnt(8)
  buffer_load_dwordx4 v[228:231], v1, s[4:7], s83 offen offset:128 nt
  s_waitcnt vmcnt(8)
  buffer_load_dwordx4 v[232:235], v1, s[4:7], s83 offen offset:2048 nt
  s_waitcnt vmcnt(8)
  buffer_load_dwordx4 v[236:239], v1, s[4:7], s83 offen offset:2176 nt
  s_waitcnt vmcnt(8)
  buffer_load_dwordx4 v[240:243], v1, s[4:7], s84 offen offset:0 nt
  s_waitcnt vmcnt(4)
  buffer_load_dwordx4 v[244:247], v1, s[4:7], s84 offen offset:128 nt
  v_min3_u32 v34, v113, v115, v117
  v_max3_u32 v35, v113, v115, v117
  v_min3_u32 v34, v34, v119, v121
  v_max3_u32 v35, v35, v119, v121
  v_min3_u32 v34, v34, v123, v125
  v_max3_u32 v35, v35, v123, v125
  v_min_u32 v34, v34, v127
  v_max_u32 v35, v35, v127
  v_xor_b32 v34, s98, v34
  v_xor_b32 v35, s98, v35
  v_or_b32 v34, v34, v35
  v_cmp_ne_u32 vcc, 0, v34
  s_cmp_lg_u64 vcc, 0
  s_cbranch_scc0 L_pok0
  s_mov_b32 s58, 20000
L_pl0:
  buffer_load_dwordx4 v[112:115], v29, s[24:27], s86 offen sc1
  buffer_load_dwordx4 v[116:119], v29, s[24:27], s87 offen sc1
  buffer_load_dwordx4 v[120:123], v29, s[24:27], s88 offen sc1
  buffer_load_dwordx4 v[124:127], v29, s[24:27], s94 offen sc1
  s_waitcnt vmcnt(0)
  v_min3_u32 v34, v113, v115, v117
  v_max3_u32 v35, v113, v115, v117
  v_min3_u32 v34, v34, v119, v121
  v_max3_u32 v35, v35, v119, v121
  v_min3_u32 v34, v34, v123, v125
  v_max3_u32 v35, v35, v123, v125
  v_min_u32 v34, v34, v127
  v_max_u32 v35, v35, v127
  v_xor_b32 v34, s98, v34
  v_xor_b32 v35, s98, v35
  v_or_b32 v34, v34, v35
  v_cmp_ne_u32 vcc, 0, v34
  s_cmp_lg_u64 vcc, 0
  s_cbranch_scc0 L_pok0
  s_sub_u32 s58, s58, 1
  s_cmp_lg_u32 s58, 0
  s_cbranch_scc1 L_pl0
L_pok0:
  v_add_f32 v112, v112, v116
  v_add_f32 v114, v114, v118
  v_add_f32 v120, v120, v124
  v_add_f32 v122, v122, v126
  v_add_f32 v112, v112, v120
  v_add_f32 v114, v114, v122
  v_cvt_pk_bf16_f32 v34, v112, v114
  v_lshlrev_b32 v112, 16, v34
  v_and_b32 v114, 0xffff0000, v34
  v_sub_f32 v108, v108, v30
  v_add_f32 v34, 1.0, v114
  v_cvt_pk_bf16_f32 v35, v108, v34
  v_lshlrev_b32 v108, 16, v35
  v_and_b32 v34, 0xffff0000, v35
  v_mul_f32 v108, v108, v31
  v_cvt_pk_bf16_f32 v108, v108, v108
  v_and_b32 v108, 0xffff0000, v108
  v_mul_f32 v108, v108, v34
  v_cvt_pk_bf16_f32 v108, v108, v108
  v_and_b32 v108, 0xffff0000, v108
  v_add_f32 v108, v108, v112
  v_cvt_pk_bf16_f32 v108, v108, v108
  v_and_b32 v32, v4, v108
  v_and_b32 v33, v5, v108
  v_and_b32 v34, v6, v108
  v_and_b32 v35, v7, v108
  s_nop 1
  v_mfma_f32_16x16x32_bf16 v[8:11], v[32:35], v[40:43], 0
  v_mfma_f32_16x16x32_bf16 v[12:15], v[32:35], v[44:47], 0
  v_and_b32 v28, 7, v0
  v_lshlrev_b32 v28, 5, v28
  v_and_b32 v29, 16, v0
  v_add_u32 v28, v28, v29
  v_and_b32 v29, 32, v0
  v_lshl_add_u32 v28, v29, 3, v28
  s_nop 0
  v_mov_b32 v32, v8
  v_mov_b32 v33, v9
  v_mov_b32 v34, v10
  v_mov_b32 v35, v11
  v_permlane32_swap_b32 v8, v32
  v_permlane32_swap_b32 v9, v33
  v_permlane32_swap_b32 v10, v34
  v_permlane32_swap_b32 v11, v35
  v_add_f32_dpp v8, v32, v8 row_ror:8 row_mask:0xf bank_mask:0xf
  v_add_f32_dpp v9, v33, v9 row_ror:8 row_mask:0xf bank_mask:0xf
  v_add_f32_dpp v10, v34, v10 row_ror:8 row_mask:0xf bank_mask:0xf
  v_add_f32_dpp v11, v35, v11 row_ror:8 row_mask:0xf bank_mask:0xf
  v_mov_b32 v36, v12
  v_mov_b32 v37, v13
  v_mov_b32 v38, v14
  v_mov_b32 v39, v15
  v_permlane32_swap_b32 v12, v36
  v_permlane32_swap_b32 v13, v37
  v_permlane32_swap_b32 v14, v38
  v_permlane32_swap_b32 v15, v39
  v_add_f32_dpp v12, v36, v12 row_ror:8 row_mask:0xf bank_mask:0xf
  v_add_f32_dpp v13, v37, v13 row_ror:8 row_mask:0xf bank_mask:0xf
  v_add_f32_dpp v14, v38, v14 row_ror:8 row_mask:0xf bank_mask:0xf
  v_add_f32_dpp v15, v39, v15 row_ror:8 row_mask:0xf bank_mask:0xf
  s_mov_b32 exec_lo, 0
  s_mov_b32 exec_hi, -1
  v_mov_b32 v8, v12
  v_mov_b32 v9, v13
  v_mov_b32 v10, v14
  v_mov_b32 v11, v15
  s_mov_b32 exec_lo, 0x00ff00ff
  s_mov_b32 exec_hi, 0x00ff00ff
  ds_add_f32 v28, v8 offset:512
  ds_add_f32 v28, v9 offset:516
  ds_add_f32 v28, v10 offset:520
  ds_add_f32 v28, v11 offset:524
  v_mov_b32 v34, 0
  v_mov_b32 v35, 1
  s_mov_b32 exec_lo, 1
  s_mov_b32 exec_hi, 0
  ds_add_rtn_u32 v36, v34, v35 offset:260
  s_mov_b64 exec, -1
  v_lshlrev_b32 v28, 3, v0
  s_lshl_b32 s3, s100, 5
  s_add_u32 s3, s3, s101
  s_lshl_b32 s3, s3, 10
  s_add_u32 s3, s3, 524288
  s_waitcnt lgkmcnt(0)
  v_readfirstlane_b32 s54, v36
  s_cmp_lg_u32 s54, 7
  s_cbranch_scc1 L_noq
  ds_read_b64 v[8:9], v28 offset:512
  v_lshlrev_b32 v28, 4, v0
  v_mov_b32 v17, s98
  v_mov_b32 v19, s98
  s_waitcnt lgkmcnt(0)
  v_mov_b32 v16, v8
  v_mov_b32 v18, v9
  buffer_store_dwordx4 v[16:19], v28, s[24:27], s3 offen
  s_add_u32 s54, s3, 1048576
  buffer_store_dwordx4 v[16:19], v28, s[24:27], s54 offen sc0 sc1
L_noq:
  s_waitcnt vmcnt(4)
  buffer_load_dwordx4 v[248:251], v1, s[4:7], s84 offen offset:2048 nt
  s_waitcnt vmcnt(4)
  buffer_load_dwordx4 v[252:255], v1, s[4:7], s84 offen offset:2176 nt
  s_cmp_eq_u32 s101, 15
  s_cselect_b32 s95, 1, 0
  s_bitcmp0_b32 s100, 0
  s_cselect_b32 s95, s95, 0
  s_cmp_lt_u32 s97, 2
  s_cselect_b32 s95, s95, 0
  s_cmp_eq_u32 s95, 0
  s_cbranch_scc1 L_nofz
  s_add_u32 s3, s100, s97
  s_lshl_b32 s3, s3, 10
  v_lshl_add_u32 v28, v0, 4, s3
  s_mov_b32 s85, 491520
  s_mov_b32 s87, 499712
  s_mov_b32 s88, 507904
  s_mov_b32 s94, 516096
  buffer_load_dwordx4 v[112:115], v28, s[24:27], s85 offen sc1
  buffer_load_dwordx4 v[116:119], v28, s[24:27], s87 offen sc1
  buffer_load_dwordx4 v[120:123], v28, s[24:27], s88 offen sc1
  buffer_load_dwordx4 v[124:127], v28, s[24:27], s94 offen sc1
L_nofz:
  s_waitcnt vmcnt(4)
  buffer_load_dwordx4 v[40:43], v1, s[8:11], 0 offen offset:0 nt
  s_waitcnt vmcnt(4)
  buffer_load_dwordx4 v[44:47], v1, s[8:11], 0 offen offset:128 nt
  s_waitcnt vmcnt(4)
  buffer_load_dwordx4 v[48:51], v1, s[8:11], 0 offen offset:2048 nt
  s_waitcnt vmcnt(4)
  buffer_load_dwordx4 v[52:55], v1, s[8:11], 0 offen offset:2176 nt
  s_waitcnt vmcnt(4)
  buffer_load_dwordx4 v[56:59], v1, s[8:11], s78 offen offset:0 nt
  s_waitcnt vmcnt(4)
  buffer_load_dwordx4 v[60:63], v1, s[8:11], s78 offen offset:128 nt
  s_waitcnt vmcnt(4)
  buffer_load_dwordx4 v[64:67], v1, s[8:11], s78 offen offset:2048 nt
  s_waitcnt vmcnt(4)
  buffer_load_dwordx4 v[68:71], v1, s[8:11], s78 offen offset:2176 nt
  s_lshl_b32 s86, s96, 13
  s_lshl_b32 s3, s97, 10
  s_add_u32 s86, s86, s3
  s_add_u32 s86, s86, 524288
  v_lshlrev_b32 v3, 4, v0
  buffer_load_dwordx4 v[104:107], v3, s[24:27], s86 offen sc1
  s_waitcnt vmcnt(5)
  buffer_load_dwordx4 v[72:75], v1, s[8:11], s79 offen offset:0 nt
  s_waitcnt vmcnt(5)
  buffer_load_dwordx4 v[76:79], v1, s[8:11], s79 offen offset:128 nt
  s_cmp_eq_u32 s95, 0
  s_cbranch_scc1 L_nofc
  s_waitcnt vmcnt(11)
  v_min3_u32 v34, v113, v115, v117
  v_max3_u32 v35, v113, v115, v117
  v_min3_u32 v34, v34, v119, v121
  v_max3_u32 v35, v35, v119, v121
  v_min3_u32 v34, v34, v123, v125
  v_max3_u32 v35, v35, v123, v125
  v_min_u32 v34, v34, v127
  v_max_u32 v35, v35, v127
  v_xor_b32 v34, s98, v34
  v_xor_b32 v35, s98, v35
  v_or_b32 v34, v34, v35
  v_cmp_ne_u32 vcc, 0, v34
  s_cmp_lg_u64 vcc, 0
  s_cbranch_scc0 L_pok1
  s_mov_b32 s58, 20000
L_pl1:
  buffer_load_dwordx4 v[112:115], v28, s[24:27], s85 offen sc1
  buffer_load_dwordx4 v[116:119], v28, s[24:27], s87 offen sc1
  buffer_load_dwordx4 v[120:123], v28, s[24:27], s88 offen sc1
  buffer_load_dwordx4 v[124:127], v28, s[24:27], s94 offen sc1
  s_waitcnt vmcnt(0)
  v_min3_u32 v34, v113, v115, v117
  v_max3_u32 v35, v113, v115, v117
  v_min3_u32 v34, v34, v119, v121
  v_max3_u32 v35, v35, v119, v121
  v_min3_u32 v34, v34, v123, v125
  v_max3_u32 v35, v35, v123, v125
  v_min_u32 v34, v34, v127
  v_max_u32 v35, v35, v127
  v_xor_b32 v34, s98, v34
  v_xor_b32 v35, s98, v35
  v_or_b32 v34, v34, v35
  v_cmp_ne_u32 vcc, 0, v34
  s_cmp_lg_u64 vcc, 0
  s_cbranch_scc0 L_pok1
  s_sub_u32 s58, s58, 1
  s_cmp_lg_u32 s58, 0
  s_cbranch_scc1 L_pl1
L_pok1:
  v_add_f32 v112, v112, v120
  v_add_f32 v114, v114, v122
  v_add_f32 v116, v116, v124
  v_add_f32 v118, v118, v126
  v_cvt_pk_bf16_f32 v112, v112, v114
  v_cvt_pk_bf16_f32 v114, v116, v118
  s_mov_b32 s3, 786432
  buffer_store_dwordx4 v[112:115], v28, s[24:27], s3 offen sc0 sc1
L_nofc:
  s_waitcnt vmcnt(5)
  buffer_load_dwordx4 v[80:83], v1, s[8:11], s79 offen offset:2048 nt
  s_waitcnt vmcnt(5)
  buffer_load_dwordx4 v[84:87], v1, s[8:11], s79 offen offset:2176 nt
  s_load_dwordx2 s[56:57], s[0:1], 96
  s_waitcnt vmcnt(5)
  buffer_load_dwordx4 v[88:91], v1, s[8:11], s80 offen offset:0 nt
  s_waitcnt vmcnt(4)
  buffer_load_dwordx4 v[92:95], v1, s[8:11], s80 offen offset:128 nt
  v_xor_b32 v32, s98, v105
  v_xor_b32 v33, s98, v107
  v_or_b32 v32, v32, v33
  v_cmp_ne_u32 vcc, 0, v32
  s_cmp_lg_u64 vcc, 0
  s_cbranch_scc0 L_pok2
  s_mov_b32 s58, 20000
L_pl2:
  s_cmp_lt_u32 s58, 19992
  s_cselect_b32 s59, s58, 0
  s_bitcmp1_b32 s59, 0
  s_cselect_b32 s59, 1048576, 0
  s_add_u32 s59, s59, s86
  buffer_load_dwordx4 v[104:107], v3, s[24:27], s59 offen sc1
  s_waitcnt vmcnt(0)
  v_xor_b32 v32, s98, v105
  v_xor_b32 v33, s98, v107
  v_or_b32 v32, v32, v33
  v_cmp_ne_u32 vcc, 0, v32
  s_cmp_lg_u64 vcc, 0
  s_cbranch_scc0 L_pok2
  s_sub_u32 s58, s58, 1
  s_cmp_lg_u32 s58, 0
  s_cbranch_scc1 L_pl2
L_pok2:
  v_mov_b32 v32, v104
  v_mov_b32 v33, v106
  v_lshlrev_b32 v3, 3, v0
  s_lshl_b32 s3, s97, 9
  v_add_u32 v36, s3, v3
  ds_write_b64 v36, v[32:33] offset:4096
  v_mov_b32 v34, 0
  v_mov_b32 v35, 1
  s_mov_b32 exec_lo, 1
  s_mov_b32 exec_hi, 0
  ds_add_u32 v34, v35 offset:264
  s_mov_b64 exec, -1
  v_mov_b32 v33, 0
  s_mov_b32 s58, 20000
L_cw0:
  ds_read_b32 v32, v33 offset:264
  s_waitcnt lgkmcnt(0)
  v_readfirstlane_b32 s59, v32
  s_cmp_ge_u32 s59, 8
  s_cbranch_scc1 L_cd0
  s_sub_u32 s58, s58, 1
  s_cmp_lg_u32 s58, 0
  s_cbranch_scc1 L_cw0
L_cd0:
  ds_read_b64 v[16:17], v3 offset:4096
  ds_read_b64 v[18:19], v3 offset:4608
  ds_read_b64 v[20:21], v3 offset:5120
  ds_read_b64 v[22:23], v3 offset:5632
  ds_read_b64 v[24:25], v3 offset:6144
  ds_read_b64 v[26:27], v3 offset:6656
  ds_read_b64 v[28:29], v3 offset:7168
  ds_read_b64 v[30:31], v3 offset:7680
  s_waitcnt vmcnt(4)
  buffer_load_dwordx4 v[96:99], v1, s[8:11], s80 offen offset:2048 nt
  s_lshl_b32 s3, s97, 8
  v_lshl_add_u32 v34, v0, 2, s3
  v_and_b32 v2, 7, v0
  v_lshl_add_u32 v35, v2, 4, s3
  s_waitcnt lgkmcnt(6)
  v_add_f32 v16, v16, v18
  v_add_f32 v17, v17, v19
  s_waitcnt lgkmcnt(4)
  v_add_f32 v20, v20, v22
  v_add_f32 v21, v21, v23
  v_add_f32 v16, v16, v20
  v_add_f32 v17, v17, v21
  s_waitcnt lgkmcnt(2)
  v_add_f32 v24, v24, v26
  v_add_f32 v25, v25, v27
  s_waitcnt lgkmcnt(0)
  v_add_f32 v28, v28, v30
  v_add_f32 v29, v29, v31
  v_add_f32 v24, v24, v28
  v_add_f32 v25, v25, v29
  v_add_f32 v16, v16, v24
  v_add_f32 v17, v17, v25
  v_cvt_pk_bf16_f32 v16, v16, v17
  ds_write_b32 v34, v16 offset:8192
  ds_read_b128 v[8:11], v35 offset:8192
  ds_read_b128 v[12:15], v35 offset:8320
  v_lshlrev_b32 v2, 5, v2
  v_and_b32 v32, 16, v0
  v_add_u32 v2, v2, v32
  s_waitcnt lgkmcnt(0)
  v_dot2_f32_bf16 v32, v128, v8, 0
  v_dot2_f32_bf16 v33, v136, v8, 0
  v_dot2_f32_bf16 v32, v129, v9, v32
  v_dot2_f32_bf16 v33, v137, v9, v33
  v_dot2_f32_bf16 v32, v130, v10, v32
  v_dot2_f32_bf16 v33, v138, v10, v33
  v_dot2_f32_bf16 v32, v131, v11, v32
  v_dot2_f32_bf16 v33, v139, v11, v33
  v_dot2_f32_bf16 v32, v132, v12, v32
  v_dot2_f32_bf16 v33, v140, v12, v33
  v_dot2_f32_bf16 v32, v133, v13, v32
  v_dot2_f32_bf16 v33, v141, v13, v33
  v_dot2_f32_bf16 v32, v134, v14, v32
  v_dot2_f32_bf16 v33, v142, v14, v33
  v_dot2_f32_bf16 v32, v135, v15, v32
  v_dot2_f32_bf16 v33, v143, v15, v33
  s_waitcnt vmcnt(4)
  buffer_load_dwordx4 v[100:103], v1, s[8:11], s80 offen offset:2176 nt
  v_add_f32_dpp v32, v32, v32 quad_perm:[1,0,3,2] row_mask:0xf bank_mask:0xf
  v_add_f32_dpp v33, v33, v33 quad_perm:[1,0,3,2] row_mask:0xf bank_mask:0xf
  s_nop 0
  v_add_f32_dpp v32, v32, v32 quad_perm:[2,3,0,1] row_mask:0xf bank_mask:0xf
  v_add_f32_dpp v33, v33, v33 quad_perm:[2,3,0,1] row_mask:0xf bank_mask:0xf
  s_nop 0
  v_add_f32_dpp v32, v32, v32 row_half_mirror row_mask:0xf bank_mask:0xf
  v_add_f32_dpp v33, v33, v33 row_half_mirror row_mask:0xf bank_mask:0xf
  v_cvt_pk_bf16_f32 v34, v32, v33
  v_lshlrev_b32 v32, 16, v34
  v_and_b32 v33, 0xffff0000, v34
  v_mul_f32 v32, 0x3db504f3, v32
  v_mul_f32 v33, 0x3db504f3, v33
  v_cvt_pk_bf16_f32 v34, v32, v33
  v_lshlrev_b32 v16, 16, v34
  v_and_b32 v17, 0xffff0000, v34
  v_dot2_f32_bf16 v32, v144, v8, 0
  v_dot2_f32_bf16 v33, v152, v8, 0
  v_dot2_f32_bf16 v32, v145, v9, v32
  v_dot2_f32_bf16 v33, v153, v9, v33
  v_dot2_f32_bf16 v32, v146, v10, v32
  v_dot2_f32_bf16 v33, v154, v10, v33
  v_dot2_f32_bf16 v32, v147, v11, v32
  v_dot2_f32_bf16 v33, v155, v11, v33
  v_dot2_f32_bf16 v32, v148, v12, v32
  v_dot2_f32_bf16 v33, v156, v12, v33
  v_dot2_f32_bf16 v32, v149, v13, v32
  v_dot2_f32_bf16 v33, v157, v13, v33
  v_dot2_f32_bf16 v32, v150, v14, v32
  v_dot2_f32_bf16 v33, v158, v14, v33
  v_dot2_f32_bf16 v32, v151, v15, v32
  v_dot2_f32_bf16 v33, v159, v15, v33
  s_waitcnt lgkmcnt(0)
  s_cmp_ge_u32 s101, 16
  s_cbranch_scc1 L_nocl
  v_mov_b32 v34, 0
  v_mov_b32 v35, 1
  s_mov_b32 exec_lo, 1
  s_mov_b32 exec_hi, 0
  ds_add_rtn_u32 v36, v34, v35 offset:272
  s_waitcnt lgkmcnt(0)
  v_readfirstlane_b32 s3, v36
  s_cmp_lg_u32 s3, 7
  s_cbranch_scc1 L_nocl
  global_atomic_add v121, v34, v35, s[56:57] sc0 sc1
  s_mov_b32 s53, 1
L_nocl:
  s_mov_b64 exec, -1
  s_waitcnt vmcnt(4)
  buffer_load_dwordx4 v[128:131], v1, s[8:11], s81 offen offset:0 nt
  v_add_f32_dpp v32, v32, v32 quad_perm:[1,0,3,2] row_mask:0xf bank_mask:0xf
  v_add_f32_dpp v33, v33, v33 quad_perm:[1,0,3,2] row_mask:0xf bank_mask:0xf
  s_nop 0
  v_add_f32_dpp v32, v32, v32 quad_perm:[2,3,0,1] row_mask:0xf bank_mask:0xf
  v_add_f32_dpp v33, v33, v33 quad_perm:[2,3,0,1] row_mask:0xf bank_mask:0xf
  s_nop 0
  v_add_f32_dpp v32, v32, v32 row_half_mirror row_mask:0xf bank_mask:0xf
  v_add_f32_dpp v33, v33, v33 row_half_mirror row_mask:0xf bank_mask:0xf
  v_cvt_pk_bf16_f32 v34, v32, v33
  v_lshlrev_b32 v32, 16, v34
  v_and_b32 v33, 0xffff0000, v34
  v_mul_f32 v32, 0x3db504f3, v32
  v_mul_f32 v33, 0x3db504f3, v33
  v_cvt_pk_bf16_f32 v34, v32, v33
  v_lshlrev_b32 v18, 16, v34
  v_and_b32 v19, 0xffff0000, v34
  v_dot2_f32_bf16 v32, v160, v8, 0
  v_dot2_f32_bf16 v33, v168, v8, 0
  v_dot2_f32_bf16 v32, v161, v9, v32
  v_dot2_f32_bf16 v33, v169, v9, v33
  v_dot2_f32_bf16 v32, v162, v10, v32
  v_dot2_f32_bf16 v33, v170, v10, v33
  v_dot2_f32_bf16 v32, v163, v11, v32
  v_dot2_f32_bf16 v33, v171, v11, v33
  v_dot2_f32_bf16 v32, v164, v12, v32
  v_dot2_f32_bf16 v33, v172, v12, v33
  v_dot2_f32_bf16 v32, v165, v13, v32
  v_dot2_f32_bf16 v33, v173, v13, v33
  v_dot2_f32_bf16 v32, v166, v14, v32
  v_dot2_f32_bf16 v33, v174, v14, v33
  v_dot2_f32_bf16 v32, v167, v15, v32
  v_dot2_f32_bf16 v33, v175, v15, v33
  s_waitcnt vmcnt(4)
  buffer_load_dwordx4 v[132:135], v1, s[8:11], s81 offen offset:128 nt
  v_add_f32_dpp v32, v32, v32 quad_perm:[1,0,3,2] row_mask:0xf bank_mask:0xf
  v_add_f32_dpp v33, v33, v33 quad_perm:[1,0,3,2] row_mask:0xf bank_mask:0xf
  s_nop 0
  v_add_f32_dpp v32, v32, v32 quad_perm:[2,3,0,1] row_mask:0xf bank_mask:0xf
  v_add_f32_dpp v33, v33, v33 quad_perm:[2,3,0,1] row_mask:0xf bank_mask:0xf
  s_nop 0
  v_add_f32_dpp v32, v32, v32 row_half_mirror row_mask:0xf bank_mask:0xf
  v_add_f32_dpp v33, v33, v33 row_half_mirror row_mask:0xf bank_mask:0xf
  v_cvt_pk_bf16_f32 v34, v32, v33
  v_lshlrev_b32 v32, 16, v34
  v_and_b32 v33, 0xffff0000, v34
  v_mul_f32 v32, 0x3db504f3, v32
  v_mul_f32 v33, 0x3db504f3, v33
  v_cvt_pk_bf16_f32 v34, v32, v33
  v_lshlrev_b32 v20, 16, v34
  v_and_b32 v21, 0xffff0000, v34
  v_dot2_f32_bf16 v32, v176, v8, 0
  v_dot2_f32_bf16 v33, v184, v8, 0
  v_dot2_f32_bf16 v32, v177, v9, v32
  v_dot2_f32_bf16 v33, v185, v9, v33
  v_dot2_f32_bf16 v32, v178, v10, v32
  v_dot2_f32_bf16 v33, v186, v10, v33
  v_dot2_f32_bf16 v32, v179, v11, v32
  v_dot2_f32_bf16 v33, v187, v11, v33
  v_dot2_f32_bf16 v32, v180, v12, v32
  v_dot2_f32_bf16 v33, v188, v12, v33
  v_dot2_f32_bf16 v32, v181, v13, v32
  v_dot2_f32_bf16 v33, v189, v13, v33
  v_dot2_f32_bf16 v32, v182, v14, v32
  v_dot2_f32_bf16 v33, v190, v14, v33
  v_dot2_f32_bf16 v32, v183, v15, v32
  v_dot2_f32_bf16 v33, v191, v15, v33
  s_waitcnt vmcnt(4)
  buffer_load_dwordx4 v[136:139], v1, s[8:11], s81 offen offset:2048 nt
  v_add_f32_dpp v32, v32, v32 quad_perm:[1,0,3,2] row_mask:0xf bank_mask:0xf
  v_add_f32_dpp v33, v33, v33 quad_perm:[1,0,3,2] row_mask:0xf bank_mask:0xf
  s_nop 0
  v_add_f32_dpp v32, v32, v32 quad_perm:[2,3,0,1] row_mask:0xf bank_mask:0xf
  v_add_f32_dpp v33, v33, v33 quad_perm:[2,3,0,1] row_mask:0xf bank_mask:0xf
  s_nop 0
  v_add_f32_dpp v32, v32, v32 row_half_mirror row_mask:0xf bank_mask:0xf
  v_add_f32_dpp v33, v33, v33 row_half_mirror row_mask:0xf bank_mask:0xf
  v_cvt_pk_bf16_f32 v34, v32, v33
  v_lshlrev_b32 v32, 16, v34
  v_and_b32 v33, 0xffff0000, v34
  v_mul_f32 v32, 0x3db504f3, v32
  v_mul_f32 v33, 0x3db504f3, v33
  v_cvt_pk_bf16_f32 v34, v32, v33
  v_lshlrev_b32 v22, 16, v34
  v_and_b32 v23, 0xffff0000, v34
  v_dot2_f32_bf16 v32, v192, v8, 0
  v_dot2_f32_bf16 v33, v200, v8, 0
  v_dot2_f32_bf16 v32, v193, v9, v32
  v_dot2_f32_bf16 v33, v201, v9, v33
  v_dot2_f32_bf16 v32, v194, v10, v32
  v_dot2_f32_bf16 v33, v202, v10, v33
  v_dot2_f32_bf16 v32, v195, v11, v32
  v_dot2_f32_bf16 v33, v203, v11, v33
  v_dot2_f32_bf16 v32, v196, v12, v32
  v_dot2_f32_bf16 v33, v204, v12, v33
  v_dot2_f32_bf16 v32, v197, v13, v32
  v_dot2_f32_bf16 v33, v205, v13, v33
  v_dot2_f32_bf16 v32, v198, v14, v32
  v_dot2_f32_bf16 v33, v206, v14, v33
  v_dot2_f32_bf16 v32, v199, v15, v32
  v_dot2_f32_bf16 v33, v207, v15, v33
  s_waitcnt vmcnt(4)
  buffer_load_dwordx4 v[140:143], v1, s[8:11], s81 offen offset:2176 nt
  v_add_f32_dpp v32, v32, v32 quad_perm:[1,0,3,2] row_mask:0xf bank_mask:0xf
  v_add_f32_dpp v33, v33, v33 quad_perm:[1,0,3,2] row_mask:0xf bank_mask:0xf
  s_nop 0
  v_add_f32_dpp v32, v32, v32 quad_perm:[2,3,0,1] row_mask:0xf bank_mask:0xf
  v_add_f32_dpp v33, v33, v33 quad_perm:[2,3,0,1] row_mask:0xf bank_mask:0xf
  s_nop 0
  v_add_f32_dpp v32, v32, v32 row_half_mirror row_mask:0xf bank_mask:0xf
  v_add_f32_dpp v33, v33, v33 row_half_mirror row_mask:0xf bank_mask:0xf
  v_cvt_pk_bf16_f32 v34, v32, v33
  v_lshlrev_b32 v32, 16, v34
  v_and_b32 v33, 0xffff0000, v34
  v_mul_f32 v32, 0x3db504f3, v32
  v_mul_f32 v33, 0x3db504f3, v33
  v_cvt_pk_bf16_f32 v34, v32, v33
  v_lshlrev_b32 v24, 16, v34
  v_and_b32 v25, 0xffff0000, v34
  v_dot2_f32_bf16 v32, v208, v8, 0
  v_dot2_f32_bf16 v33, v216, v8, 0
  v_dot2_f32_bf16 v32, v209, v9, v32
  v_dot2_f32_bf16 v33, v217, v9, v33
  v_dot2_f32_bf16 v32, v210, v10, v32
  v_dot2_f32_bf16 v33, v218, v10, v33
  v_dot2_f32_bf16 v32, v211, v11, v32
  v_dot2_f32_bf16 v33, v219, v11, v33
  v_dot2_f32_bf16 v32, v212, v12, v32
  v_dot2_f32_bf16 v33, v220, v12, v33
  v_dot2_f32_bf16 v32, v213, v13, v32
  v_dot2_f32_bf16 v33, v221, v13, v33
  v_dot2_f32_bf16 v32, v214, v14, v32
  v_dot2_f32_bf16 v33, v222, v14, v33
  v_dot2_f32_bf16 v32, v215, v15, v32
  v_dot2_f32_bf16 v33, v223, v15, v33
  s_waitcnt vmcnt(4)
  buffer_load_dwordx4 v[144:147], v1, s[8:11], s82 offen offset:0 nt
  v_add_f32_dpp v32, v32, v32 quad_perm:[1,0,3,2] row_mask:0xf bank_mask:0xf
  v_add_f32_dpp v33, v33, v33 quad_perm:[1,0,3,2] row_mask:0xf bank_mask:0xf
  s_nop 0
  v_add_f32_dpp v32, v32, v32 quad_perm:[2,3,0,1] row_mask:0xf bank_mask:0xf
  v_add_f32_dpp v33, v33, v33 quad_perm:[2,3,0,1] row_mask:0xf bank_mask:0xf
  s_nop 0
  v_add_f32_dpp v32, v32, v32 row_half_mirror row_mask:0xf bank_mask:0xf
  v_add_f32_dpp v33, v33, v33 row_half_mirror row_mask:0xf bank_mask:0xf
  v_cvt_pk_bf16_f32 v34, v32, v33
  v_lshlrev_b32 v32, 16, v34
  v_and_b32 v33, 0xffff0000, v34
  v_mul_f32 v32, 0x3db504f3, v32
  v_mul_f32 v33, 0x3db504f3, v33
  v_cvt_pk_bf16_f32 v34, v32, v33
  v_lshlrev_b32 v26, 16, v34
  v_and_b32 v27, 0xffff0000, v34
  v_dot2_f32_bf16 v32, v224, v8, 0
  v_dot2_f32_bf16 v33, v232, v8, 0
  v_dot2_f32_bf16 v32, v225, v9, v32
  v_dot2_f32_bf16 v33, v233, v9, v33
  v_dot2_f32_bf16 v32, v226, v10, v32
  v_dot2_f32_bf16 v33, v234, v10, v33
  v_dot2_f32_bf16 v32, v227, v11, v32
  v_dot2_f32_bf16 v33, v235, v11, v33
  v_dot2_f32_bf16 v32, v228, v12, v32
  v_dot2_f32_bf16 v33, v236, v12, v33
  v_dot2_f32_bf16 v32, v229, v13, v32
  v_dot2_f32_bf16 v33, v237, v13, v33
  v_dot2_f32_bf16 v32, v230, v14, v32
  v_dot2_f32_bf16 v33, v238, v14, v33
  v_dot2_f32_bf16 v32, v231, v15, v32
  v_dot2_f32_bf16 v33, v239, v15, v33
  s_waitcnt vmcnt(4)
  buffer_load_dwordx4 v[148:151], v1, s[8:11], s82 offen offset:128 nt
  v_add_f32_dpp v32, v32, v32 quad_perm:[1,0,3,2] row_mask:0xf bank_mask:0xf
  v_add_f32_dpp v33, v33, v33 quad_perm:[1,0,3,2] row_mask:0xf bank_mask:0xf
  s_nop 0
  v_add_f32_dpp v32, v32, v32 quad_perm:[2,3,0,1] row_mask:0xf bank_mask:0xf
  v_add_f32_dpp v33, v33, v33 quad_perm:[2,3,0,1] row_mask:0xf bank_mask:0xf
  s_nop 0
  v_add_f32_dpp v32, v32, v32 row_half_mirror row_mask:0xf bank_mask:0xf
  v_add_f32_dpp v33, v33, v33 row_half_mirror row_mask:0xf bank_mask:0xf
  v_cvt_pk_bf16_f32 v34, v32, v33
  v_lshlrev_b32 v32, 16, v34
  v_and_b32 v33, 0xffff0000, v34
  v_mul_f32 v32, 0x3db504f3, v32
  v_mul_f32 v33, 0x3db504f3, v33
  v_cvt_pk_bf16_f32 v34, v32, v33
  v_lshlrev_b32 v28, 16, v34
  v_and_b32 v29, 0xffff0000, v34
  v_dot2_f32_bf16 v32, v240, v8, 0
  v_dot2_f32_bf16 v33, v248, v8, 0
  v_dot2_f32_bf16 v32, v241, v9, v32
  v_dot2_f32_bf16 v33, v249, v9, v33
  v_dot2_f32_bf16 v32, v242, v10, v32
  v_dot2_f32_bf16 v33, v250, v10, v33
  v_dot2_f32_bf16 v32, v243, v11, v32
  v_dot2_f32_bf16 v33, v251, v11, v33
  v_dot2_f32_bf16 v32, v244, v12, v32
  v_dot2_f32_bf16 v33, v252, v12, v33
  v_dot2_f32_bf16 v32, v245, v13, v32
  v_dot2_f32_bf16 v33, v253, v13, v33
  v_dot2_f32_bf16 v32, v246, v14, v32
  v_dot2_f32_bf16 v33, v254, v14, v33
  v_dot2_f32_bf16 v32, v247, v15, v32
  v_dot2_f32_bf16 v33, v255, v15, v33
  s_waitcnt vmcnt(4)
  buffer_load_dwordx4 v[152:155], v1, s[8:11], s82 offen offset:2048 nt
  v_add_f32_dpp v32, v32, v32 quad_perm:[1,0,3,2] row_mask:0xf bank_mask:0xf
  v_add_f32_dpp v33, v33, v33 quad_perm:[1,0,3,2] row_mask:0xf bank_mask:0xf
  s_nop 0
  v_add_f32_dpp v32, v32, v32 quad_perm:[2,3,0,1] row_mask:0xf bank_mask:0xf
  v_add_f32_dpp v33, v33, v33 quad_perm:[2,3,0,1] row_mask:0xf bank_mask:0xf
  s_nop 0
  v_add_f32_dpp v32, v32, v32 row_half_mirror row_mask:0xf bank_mask:0xf
  v_add_f32_dpp v33, v33, v33 row_half_mirror row_mask:0xf bank_mask:0xf
  v_cvt_pk_bf16_f32 v34, v32, v33
  v_lshlrev_b32 v32, 16, v34
  v_and_b32 v33, 0xffff0000, v34
  v_mul_f32 v32, 0x3db504f3, v32
  v_mul_f32 v33, 0x3db504f3, v33
  v_cvt_pk_bf16_f32 v34, v32, v33
  v_lshlrev_b32 v30, 16, v34
  v_and_b32 v31, 0xffff0000, v34
  v_max3_f32 v32, v16, v17, v18
  v_max3_f32 v33, v19, v20, v21
  v_max3_f32 v32, v32, v22, v23
  v_max3_f32 v33, v33, v24, v25
  v_max3_f32 v32, v32, v26, v27
  v_max3_f32 v33, v33, v28, v29
  v_max3_f32 v32, v32, v30, v31
  v_max_f32 v32, v32, v33
  s_nop 1
  v_max_f32_dpp v32, v32, v32 row_ror:8 row_mask:0xf bank_mask:0xf
  s_nop 1
  v_max_f32_dpp v32, v32, v32 row_bcast:15 row_mask:0xa bank_mask:0xf
  s_nop 1
  v_max_f32_dpp v32, v32, v32 row_bcast:31 row_mask:0xc bank_mask:0xf
  s_nop 0
  v_readlane_b32 s54, v32, 63
  s_nop 1
  v_mov_b32 v33, s54
  v_mov_b32 v122, s54
  v_mul_f32 v33, 0xbfb8aa3b, v33
  v_fmamk_f32 v16, v16, 0x3fb8aa3b, v33
  v_fmamk_f32 v17, v17, 0x3fb8aa3b, v33
  v_fmamk_f32 v18, v18, 0x3fb8aa3b, v33
  v_fmamk_f32 v19, v19, 0x3fb8aa3b, v33
  v_fmamk_f32 v20, v20, 0x3fb8aa3b, v33
  v_fmamk_f32 v21, v21, 0x3fb8aa3b, v33
  v_fmamk_f32 v22, v22, 0x3fb8aa3b, v33
  v_fmamk_f32 v23, v23, 0x3fb8aa3b, v33
  v_fmamk_f32 v24, v24, 0x3fb8aa3b, v33
  v_fmamk_f32 v25, v25, 0x3fb8aa3b, v33
  v_fmamk_f32 v26, v26, 0x3fb8aa3b, v33
  v_fmamk_f32 v27, v27, 0x3fb8aa3b, v33
  v_fmamk_f32 v28, v28, 0x3fb8aa3b, v33
  v_fmamk_f32 v29, v29, 0x3fb8aa3b, v33
  v_fmamk_f32 v30, v30, 0x3fb8aa3b, v33
  v_fmamk_f32 v31, v31, 0x3fb8aa3b, v33
  v_exp_f32 v16, v16
  v_exp_f32 v17, v17
  v_exp_f32 v18, v18
  v_exp_f32 v19, v19
  v_exp_f32 v20, v20
  v_exp_f32 v21, v21
  v_exp_f32 v22, v22
  v_exp_f32 v23, v23
  v_exp_f32 v24, v24
  v_exp_f32 v25, v25
  v_exp_f32 v26, v26
  v_exp_f32 v27, v27
  v_exp_f32 v28, v28
  v_exp_f32 v29, v29
  v_exp_f32 v30, v30
  v_exp_f32 v31, v31
  v_add_f32 v35, v16, v17
  v_add_f32 v34, v18, v19
  v_add_f32 v35, v35, v20
  v_add_f32 v34, v34, v21
  v_add_f32 v35, v35, v22
  v_add_f32 v34, v34, v23
  v_add_f32 v35, v35, v24
  v_add_f32 v34, v34, v25
  v_add_f32 v35, v35, v26
  v_add_f32 v34, v34, v27
  v_add_f32 v35, v35, v28
  v_add_f32 v34, v34, v29
  v_add_f32 v35, v35, v30
  v_add_f32 v34, v34, v31
  v_add_f32 v35, v34, v35
  s_waitcnt vmcnt(4)
  buffer_load_dwordx4 v[156:159], v1, s[8:11], s82 offen offset:2176 nt
  v_cvt_pk_bf16_f32 v16, v16, v16
  v_cvt_pk_bf16_f32 v17, v17, v17
  v_cvt_pk_bf16_f32 v18, v18, v18
  v_cvt_pk_bf16_f32 v19, v19, v19
  v_cvt_pk_bf16_f32 v20, v20, v20
  v_cvt_pk_bf16_f32 v21, v21, v21
  v_cvt_pk_bf16_f32 v22, v22, v22
  v_cvt_pk_bf16_f32 v23, v23, v23
  v_cvt_pk_bf16_f32 v24, v24, v24
  v_cvt_pk_bf16_f32 v25, v25, v25
  v_cvt_pk_bf16_f32 v26, v26, v26
  v_cvt_pk_bf16_f32 v27, v27, v27
  v_cvt_pk_bf16_f32 v28, v28, v28
  v_cvt_pk_bf16_f32 v29, v29, v29
  v_cvt_pk_bf16_f32 v30, v30, v30
  v_cvt_pk_bf16_f32 v31, v31, v31
  v_add_f32_dpp v35, v35, v35 row_ror:8 row_mask:0xf bank_mask:0xf
  s_nop 1
  v_add_f32_dpp v35, v35, v35 row_bcast:15 row_mask:0xa bank_mask:0xf
  s_nop 1
  v_add_f32_dpp v35, v35, v35 row_bcast:31 row_mask:0xc bank_mask:0xf
  s_lshl_b32 s3, s96, 10
  s_and_b32 s55, s101, 7
  s_lshl_b32 s55, s55, 7
  s_add_u32 s3, s3, s55
  s_lshl_b32 s55, s97, 4
  s_add_u32 s3, s3, s55
  s_add_u32 s3, s3, 262144
  v_mov_b32 v36, v122
  v_mov_b32 v37, s98
  v_mov_b32 v38, v35
  v_mov_b32 v39, s98
  v_mov_b32 v34, 0
  s_mov_b32 exec_lo, 0
  s_mov_b32 exec_hi, 0x80000000
  buffer_store_dwordx4 v[36:39], v34, s[24:27], s3 offen
  s_add_u32 s55, s3, 1048576
  buffer_store_dwordx4 v[36:39], v34, s[24:27], s55 offen sc0 sc1
  s_mov_b64 exec, -1
  v_lshrrev_b32 v126, 3, v0
  v_lshlrev_b32 v126, 12, v126
  v_and_b32 v36, 7, v0
  v_lshl_add_u32 v126, v36, 4, v126
  s_lshl_b32 s3, s100, 19
  s_bfe_u32 s54, s101, 0x10003
  s_lshl_b32 s54, s54, 18
  s_add_u32 s3, s3, s54
  s_lshl_b32 s54, s97, 15
  s_add_u32 s3, s3, s54
  s_and_b32 s54, s101, 7
  s_lshl_b32 s54, s54, 7
  s_add_u32 s95, s3, s54
  s_cmp_ge_u32 s101, 16
  s_cselect_b32 s18, s18, 0
  buffer_load_dwordx4 v[192:195], v126, s[16:19], s95 offen offset:0 nt
  s_cmp_eq_u32 s53, 0
  s_cbranch_scc1 L_nocp
  s_waitcnt vmcnt(9)
  s_mov_b32 exec_lo, 1
  s_mov_b32 exec_hi, 0
  v_add_u32 v121, 1, v121
  v_mov_b32 v36, 0
  ds_write_b32 v36, v121 offset:276
  s_mov_b64 exec, -1
L_nocp:
  s_waitcnt vmcnt(5)
  buffer_load_dwordx4 v[160:163], v1, s[8:11], s83 offen offset:0 nt
  s_waitcnt vmcnt(5)
  buffer_load_dwordx4 v[164:167], v1, s[8:11], s83 offen offset:128 nt
  v_and_b32 v32, v4, v16
  v_and_b32 v33, v5, v16
  v_and_b32 v34, v6, v16
  v_and_b32 v35, v7, v16
  s_nop 1
  v_mfma_f32_16x16x32_bf16 v[8:11], v[32:35], v[40:43], 0
  v_mfma_f32_16x16x32_bf16 v[12:15], v[32:35], v[44:47], 0
  buffer_load_dwordx4 v[196:199], v126, s[16:19], s95 offen offset:1024 nt
  s_lshl_b32 s87, s96, 10
  s_add_u32 s87, s87, 262144
  v_lshlrev_b32 v123, 4, v0
  buffer_load_dwordx4 v[108:111], v123, s[24:27], s87 offen sc1
  s_waitcnt vmcnt(7)
  buffer_load_dwordx4 v[168:171], v1, s[8:11], s83 offen offset:2048 nt
  s_waitcnt vmcnt(7)
  buffer_load_dwordx4 v[172:175], v1, s[8:11], s83 offen offset:2176 nt
  v_and_b32 v36, v4, v17
  v_and_b32 v37, v5, v17
  v_and_b32 v38, v6, v17
  v_and_b32 v39, v7, v17
  s_nop 1
  v_mfma_f32_16x16x32_bf16 v[8:11], v[36:39], v[48:51], v[8:11]
  v_mfma_f32_16x16x32_bf16 v[12:15], v[36:39], v[52:55], v[12:15]
  buffer_load_dwordx4 v[200:203], v126, s[16:19], s95 offen offset:2048 nt
  s_waitcnt vmcnt(8)
  buffer_load_dwordx4 v[176:179], v1, s[8:11], s84 offen offset:0 nt
  s_waitcnt vmcnt(7)
  buffer_load_dwordx4 v[180:183], v1, s[8:11], s84 offen offset:128 nt
  v_and_b32 v32, v4, v18
  v_and_b32 v33, v5, v18
  v_and_b32 v34, v6, v18
  v_and_b32 v35, v7, v18
  s_nop 1
  v_mfma_f32_16x16x32_bf16 v[8:11], v[32:35], v[56:59], v[8:11]
  v_mfma_f32_16x16x32_bf16 v[12:15], v[32:35], v[60:63], v[12:15]
  buffer_load_dwordx4 v[204:207], v126, s[16:19], s95 offen offset:3072 nt
  s_waitcnt vmcnt(8)
  buffer_load_dwordx4 v[184:187], v1, s[8:11], s84 offen offset:2048 nt
  s_waitcnt vmcnt(6)
  buffer_load_dwordx4 v[188:191], v1, s[8:11], s84 offen offset:2176 nt
  v_and_b32 v36, v4, v19
  v_and_b32 v37, v5, v19
  v_and_b32 v38, v6, v19
  v_and_b32 v39, v7, v19
  s_nop 1
  v_mfma_f32_16x16x32_bf16 v[8:11], v[36:39], v[64:67], v[8:11]
  v_mfma_f32_16x16x32_bf16 v[12:15], v[36:39], v[68:71], v[12:15]
  v_and_b32 v32, v4, v20
  v_and_b32 v33, v5, v20
  v_and_b32 v34, v6, v20
  v_and_b32 v35, v7, v20
  s_nop 1
  v_mfma_f32_16x16x32_bf16 v[8:11], v[32:35], v[72:75], v[8:11]
  v_mfma_f32_16x16x32_bf16 v[12:15], v[32:35], v[76:79], v[12:15]
  v_and_b32 v36, v4, v21
  v_and_b32 v37, v5, v21
  v_and_b32 v38, v6, v21
  v_and_b32 v39, v7, v21
  s_nop 1
  v_mfma_f32_16x16x32_bf16 v[8:11], v[36:39], v[80:83], v[8:11]
  v_mfma_f32_16x16x32_bf16 v[12:15], v[36:39], v[84:87], v[12:15]
  v_and_b32 v32, v4, v22
  v_and_b32 v33, v5, v22
  v_and_b32 v34, v6, v22
  v_and_b32 v35, v7, v22
  s_nop 1
  v_mfma_f32_16x16x32_bf16 v[8:11], v[32:35], v[88:91], v[8:11]
  v_mfma_f32_16x16x32_bf16 v[12:15], v[32:35], v[92:95], v[12:15]
  v_and_b32 v36, v4, v23
  v_and_b32 v37, v5, v23
  v_and_b32 v38, v6, v23
  v_and_b32 v39, v7, v23
  s_nop 1
  v_mfma_f32_16x16x32_bf16 v[8:11], v[36:39], v[96:99], v[8:11]
  v_mfma_f32_16x16x32_bf16 v[12:15], v[36:39], v[100:103], v[12:15]
  v_and_b32 v32, v4, v24
  v_and_b32 v33, v5, v24
  v_and_b32 v34, v6, v24
  v_and_b32 v35, v7, v24
  s_nop 1
  v_mfma_f32_16x16x32_bf16 v[8:11], v[32:35], v[128:131], v[8:11]
  v_mfma_f32_16x16x32_bf16 v[12:15], v[32:35], v[132:135], v[12:15]
  v_and_b32 v36, v4, v25
  v_and_b32 v37, v5, v25
  v_and_b32 v38, v6, v25
  v_and_b32 v39, v7, v25
  s_nop 1
  v_mfma_f32_16x16x32_bf16 v[8:11], v[36:39], v[136:139], v[8:11]
  v_mfma_f32_16x16x32_bf16 v[12:15], v[36:39], v[140:143], v[12:15]
  v_and_b32 v32, v4, v26
  v_and_b32 v33, v5, v26
  v_and_b32 v34, v6, v26
  v_and_b32 v35, v7, v26
  s_nop 1
  v_mfma_f32_16x16x32_bf16 v[8:11], v[32:35], v[144:147], v[8:11]
  v_mfma_f32_16x16x32_bf16 v[12:15], v[32:35], v[148:151], v[12:15]
  v_and_b32 v36, v4, v27
  v_and_b32 v37, v5, v27
  v_and_b32 v38, v6, v27
  v_and_b32 v39, v7, v27
  s_nop 1
  v_mfma_f32_16x16x32_bf16 v[8:11], v[36:39], v[152:155], v[8:11]
  v_mfma_f32_16x16x32_bf16 v[12:15], v[36:39], v[156:159], v[12:15]
  v_xor_b32 v124, s98, v109
  v_xor_b32 v125, s98, v111
  v_or_b32 v124, v124, v125
  v_cmp_ne_u32 vcc, 0, v124
  s_cmp_lg_u64 vcc, 0
  s_cbranch_scc0 L_pok3
  s_mov_b32 s58, 20000
L_pl3:
  s_cmp_lt_u32 s58, 19992
  s_cselect_b32 s59, s58, 0
  s_bitcmp1_b32 s59, 0
  s_cselect_b32 s59, 1048576, 0
  s_add_u32 s59, s59, s87
  buffer_load_dwordx4 v[108:111], v123, s[24:27], s59 offen sc1
  s_waitcnt vmcnt(0)
  v_xor_b32 v124, s98, v109
  v_xor_b32 v125, s98, v111
  v_or_b32 v124, v124, v125
  v_cmp_ne_u32 vcc, 0, v124
  s_cmp_lg_u64 vcc, 0
  s_cbranch_scc0 L_pok3
  s_sub_u32 s58, s58, 1
  s_cmp_lg_u32 s58, 0
  s_cbranch_scc1 L_pl3
L_pok3:
  v_mov_b32 v124, v108
  s_nop 1
  v_max_f32_dpp v124, v124, v124 row_ror:8 row_mask:0xf bank_mask:0xf
  s_nop 1
  v_max_f32_dpp v124, v124, v124 row_ror:4 row_mask:0xf bank_mask:0xf
  s_nop 1
  v_max_f32_dpp v124, v124, v124 row_ror:2 row_mask:0xf bank_mask:0xf
  s_nop 1
  v_max_f32_dpp v124, v124, v124 row_ror:1 row_mask:0xf bank_mask:0xf
  s_nop 1
  v_max_f32_dpp v124, v124, v124 row_bcast:15 row_mask:0xa bank_mask:0xf
  s_nop 1
  v_max_f32_dpp v124, v124, v124 row_bcast:31 row_mask:0xc bank_mask:0xf
  s_nop 0
  v_readlane_b32 s54, v124, 63
  s_nop 1
  v_subrev_f32 v124, s54, v108
  v_subrev_f32 v125, s54, v122
  v_mul_f32 v124, 0x3fb8aa3b, v124
  v_mul_f32 v125, 0x3fb8aa3b, v125
  v_exp_f32 v124, v124
  v_exp_f32 v125, v125
  v_mul_f32 v124, v124, v110
  s_nop 1
  v_add_f32_dpp v124, v124, v124 row_ror:8 row_mask:0xf bank_mask:0xf
  s_nop 1
  v_add_f32_dpp v124, v124, v124 row_ror:4 row_mask:0xf bank_mask:0xf
  s_nop 1
  v_add_f32_dpp v124, v124, v124 row_ror:2 row_mask:0xf bank_mask:0xf
  s_nop 1
  v_add_f32_dpp v124, v124, v124 row_ror:1 row_mask:0xf bank_mask:0xf
  s_nop 1
  v_add_f32_dpp v124, v124, v124 row_bcast:15 row_mask:0xa bank_mask:0xf
  s_nop 1
  v_add_f32_dpp v124, v124, v124 row_bcast:31 row_mask:0xc bank_mask:0xf
  s_nop 0
  v_readlane_b32 s54, v124, 63
  s_nop 1
  v_rcp_f32 v124, s54
  s_nop 0
  v_mul_f32 v120, v124, v125
  v_and_b32 v32, v4, v28
  v_and_b32 v33, v5, v28
  v_and_b32 v34, v6, v28
  v_and_b32 v35, v7, v28
  s_nop 1
  v_mfma_f32_16x16x32_bf16 v[8:11], v[32:35], v[160:163], v[8:11]
  v_mfma_f32_16x16x32_bf16 v[12:15], v[32:35], v[164:167], v[12:15]
  s_waitcnt vmcnt(6)
  v_and_b32 v36, v4, v29
  v_and_b32 v37, v5, v29
  v_and_b32 v38, v6, v29
  v_and_b32 v39, v7, v29
  s_nop 1
  v_mfma_f32_16x16x32_bf16 v[8:11], v[36:39], v[168:171], v[8:11]
  v_mfma_f32_16x16x32_bf16 v[12:15], v[36:39], v[172:175], v[12:15]
  s_waitcnt vmcnt(3)
  v_and_b32 v32, v4, v30
  v_and_b32 v33, v5, v30
  v_and_b32 v34, v6, v30
  v_and_b32 v35, v7, v30
  s_nop 1
  v_mfma_f32_16x16x32_bf16 v[8:11], v[32:35], v[176:179], v[8:11]
  v_mfma_f32_16x16x32_bf16 v[12:15], v[32:35], v[180:183], v[12:15]
  s_waitcnt vmcnt(0)
  v_and_b32 v36, v4, v31
  v_and_b32 v37, v5, v31
  v_and_b32 v38, v6, v31
  v_and_b32 v39, v7, v31
  s_nop 1
  v_mfma_f32_16x16x32_bf16 v[8:11], v[36:39], v[184:187], v[8:11]
  v_mfma_f32_16x16x32_bf16 v[12:15], v[36:39], v[188:191], v[12:15]
  s_cmp_ge_u32 s101, 16
  s_cbranch_scc1 L_norole
  v_mov_b32 v41, 0
  s_mov_b32 s58, 20000
L_rw:
  ds_read_b32 v42, v41 offset:276
  s_waitcnt lgkmcnt(0)
  v_readfirstlane_b32 s52, v42
  s_cmp_lg_u32 s52, 0
  s_cbranch_scc1 L_rg
  s_sub_u32 s58, s58, 1
  s_cmp_lg_u32 s58, 0
  s_cbranch_scc1 L_rw
L_rg:
  s_sub_u32 s52, s52, 1
  s_cmp_lt_u32 s52, 43
  s_cselect_b32 s52, s52, 255
L_norole:
  s_cmp_ge_u32 s52, 64
  s_cbranch_scc1 L_noearly
  s_cmp_eq_u32 s97, 0
  s_cbranch_scc1 L_noearly
  s_cmp_ge_u32 s97, 4
  s_cbranch_scc1 L_noearly
  s_mov_b32 s85, 786432
  v_lshrrev_b32 v52, 3, v0
  s_lshl_b32 s3, s97, 6
  v_add_u32 v3, s3, v52
  v_mul_u32_u24 v3, 2752, v3
  v_and_b32 v53, 3, v0
  v_lshl_add_u32 v3, v53, 4, v3
  s_lshl_b32 s3, s52, 6
  v_add_u32 v3, s3, v3
  s_mov_b32 s89, 22016
  s_mov_b32 s90, 44032
  s_mov_b32 s91, 66048
  s_mov_b32 s92, 88064
  s_mov_b32 s93, 110080
  s_mov_b32 s94, 132096
  s_mov_b32 s95, 154112
  v_lshlrev_b32 v50, 12, v52
  v_and_b32 v53, 7, v0
  v_lshl_add_u32 v50, v53, 4, v50
  s_lshl_b32 s3, s52, 15
  s_lshl_b32 s55, s97, 7
  s_add_u32 s3, s3, s55
  v_add_u32 v50, s3, v50
  v_and_b32 v53, 15, v0
  v_lshrrev_b32 v52, 4, v0
  v_lshl_add_u32 v53, v53, 2, v52
  s_lshl_b32 s3, s97, 6
  v_add_u32 v193, s3, v53
  v_lshlrev_b32 v52, 1, v193
  v_mov_b32 v192, 0
  v_lshlrev_b32 v194, 4, v193
  buffer_load_dwordx4 v[184:187], v194, s[24:27], s85 offen sc1
  buffer_load_short_d16_hi v192, v52, s[40:43], 0 offen nt
  s_mov_b32 exec_lo, 0x0f0f0f0f
  s_mov_b32 exec_hi, 0x0f0f0f0f
  buffer_load_dwordx4 v[128:131], v3, s[28:31], 0 offen nt
  buffer_load_dwordx4 v[132:135], v3, s[28:31], s89 offen nt
  buffer_load_dwordx4 v[136:139], v3, s[28:31], s90 offen nt
  buffer_load_dwordx4 v[140:143], v3, s[28:31], s91 offen nt
  buffer_load_dwordx4 v[144:147], v3, s[28:31], s92 offen nt
  buffer_load_dwordx4 v[148:151], v3, s[28:31], s93 offen nt
  buffer_load_dwordx4 v[152:155], v3, s[28:31], s94 offen nt
  buffer_load_dwordx4 v[156:159], v3, s[28:31], s95 offen nt
  s_mov_b32 exec_lo, 0xf0f0f0f0
  s_mov_b32 exec_hi, 0xf0f0f0f0
  buffer_load_dwordx4 v[128:131], v3, s[32:35], 0 offen nt
  buffer_load_dwordx4 v[132:135], v3, s[32:35], s89 offen nt
  buffer_load_dwordx4 v[136:139], v3, s[32:35], s90 offen nt
  buffer_load_dwordx4 v[140:143], v3, s[32:35], s91 offen nt
  buffer_load_dwordx4 v[144:147], v3, s[32:35], s92 offen nt
  buffer_load_dwordx4 v[148:151], v3, s[32:35], s93 offen nt
  buffer_load_dwordx4 v[152:155], v3, s[32:35], s94 offen nt
  buffer_load_dwordx4 v[156:159], v3, s[32:35], s95 offen nt
  s_mov_b64 exec, -1
  buffer_load_dwordx4 v[160:163], v50, s[36:39], 0 offen offset:0 nt
  buffer_load_dwordx4 v[164:167], v50, s[36:39], 0 offen offset:1024 nt
  buffer_load_dwordx4 v[168:171], v50, s[36:39], 0 offen offset:2048 nt
  buffer_load_dwordx4 v[172:175], v50, s[36:39], 0 offen offset:3072 nt
L_noearly:
  s_setprio 2
  v_and_b32 v2, 7, v0
  v_lshlrev_b32 v2, 5, v2
  v_and_b32 v32, 16, v0
  v_add_u32 v2, v2, v32
  s_lshl_b32 s3, s97, 9
  v_add_u32 v40, s3, v2
  v_mov_b32 v32, v8
  v_mov_b32 v33, v9
  v_mov_b32 v34, v10
  v_mov_b32 v35, v11
  v_permlane32_swap_b32 v8, v32
  v_permlane32_swap_b32 v9, v33
  v_permlane32_swap_b32 v10, v34
  v_permlane32_swap_b32 v11, v35
  v_add_f32_dpp v8, v32, v8 row_ror:8 row_mask:0xf bank_mask:0xf
  v_add_f32_dpp v9, v33, v9 row_ror:8 row_mask:0xf bank_mask:0xf
  v_add_f32_dpp v10, v34, v10 row_ror:8 row_mask:0xf bank_mask:0xf
  v_add_f32_dpp v11, v35, v11 row_ror:8 row_mask:0xf bank_mask:0xf
  v_mov_b32 v36, v12
  v_mov_b32 v37, v13
  v_mov_b32 v38, v14
  v_mov_b32 v39, v15
  v_permlane32_swap_b32 v12, v36
  v_permlane32_swap_b32 v13, v37
  v_permlane32_swap_b32 v14, v38
  v_permlane32_swap_b32 v15, v39
  v_add_f32_dpp v12, v36, v12 row_ror:8 row_mask:0xf bank_mask:0xf
  v_add_f32_dpp v13, v37, v13 row_ror:8 row_mask:0xf bank_mask:0xf
  v_add_f32_dpp v14, v38, v14 row_ror:8 row_mask:0xf bank_mask:0xf
  v_add_f32_dpp v15, v39, v15 row_ror:8 row_mask:0xf bank_mask:0xf
  v_mul_f32 v8, v8, v120
  v_mul_f32 v9, v9, v120
  v_mul_f32 v10, v10, v120
  v_mul_f32 v11, v11, v120
  v_mul_f32 v12, v12, v120
  v_mul_f32 v13, v13, v120
  v_mul_f32 v14, v14, v120
  v_mul_f32 v15, v15, v120
  s_mov_b32 exec_lo, 0x00ff00ff
  s_mov_b32 exec_hi, 0
  ds_write_b128 v40, v[8:11] offset:10240
  ds_write_b128 v40, v[12:15] offset:10496
  s_mov_b64 exec, -1
  v_lshlrev_b32 v37, 3, v0
  v_and_b32 v41, 7, v0
  v_lshlrev_b32 v41, 9, v41
  v_lshrrev_b32 v42, 3, v0
  v_lshl_add_u32 v41, v42, 4, v41
  s_lshl_b32 s88, s100, 14
  s_bfe_u32 s3, s101, 0x10003
  s_lshl_b32 s3, s3, 13
  s_add_u32 s88, s88, s3
  s_lshr_b32 s3, s97, 2
  s_lshl_b32 s3, s3, 12
  s_add_u32 s88, s88, s3
  s_and_b32 s3, s97, 3
  s_lshl_b32 s3, s3, 7
  s_add_u32 s88, s88, s3
  s_add_u32 s88, s88, 327680
  s_waitcnt lgkmcnt(0)
  s_barrier
  s_setprio 3
  s_cmp_lg_u32 s97, 0
  s_cbranch_scc1 L_notO
  ds_read_b64 v[16:17], v37 offset:10240
  ds_read_b64 v[18:19], v37 offset:10752
  ds_read_b64 v[20:21], v37 offset:11264
  ds_read_b64 v[22:23], v37 offset:11776
  ds_read_b64 v[24:25], v37 offset:12288
  ds_read_b64 v[26:27], v37 offset:12800
  ds_read_b64 v[28:29], v37 offset:13312
  ds_read_b64 v[30:31], v37 offset:13824
  s_lshl_b32 s3, s100, 5
  s_add_u32 s3, s3, s101
  s_lshl_b32 s3, s3, 9
  s_add_u32 s3, s3, 327680
  s_waitcnt lgkmcnt(6)
  v_add_f32 v16, v16, v18
  v_add_f32 v17, v17, v19
  s_waitcnt lgkmcnt(4)
  v_add_f32 v20, v20, v22
  v_add_f32 v21, v21, v23
  v_add_f32 v16, v16, v20
  v_add_f32 v17, v17, v21
  s_waitcnt lgkmcnt(2)
  v_add_f32 v24, v24, v26
  v_add_f32 v25, v25, v27
  s_waitcnt lgkmcnt(0)
  v_add_f32 v28, v28, v30
  v_add_f32 v29, v29, v31
  v_add_f32 v24, v24, v28
  v_add_f32 v25, v25, v29
  v_add_f32 v16, v16, v24
  v_add_f32 v17, v17, v25
  v_cvt_pk_bf16_f32 v16, v16, v17
  v_mov_b32 v17, s98
  buffer_store_dwordx2 v[16:17], v37, s[24:27], s3 offen
  s_add_u32 s55, s3, 1048576
  buffer_store_dwordx2 v[16:17], v37, s[24:27], s55 offen sc0 sc1
L_notO:
  s_cmp_lt_u32 s101, 16
  s_cbranch_scc1 L_nowo
  buffer_load_dwordx4 v[44:47], v41, s[24:27], s88 offen sc1
  s_waitcnt vmcnt(0)
  s_lshl_b32 s3, s97, 8
  v_add_u32 v48, s3, v2
  v_lshlrev_b32 v49, 2, v0
  v_xor_b32 v52, s98, v45
  v_xor_b32 v53, s98, v47
  v_or_b32 v52, v52, v53
  v_cmp_ne_u32 vcc, 0, v52
  s_cmp_lg_u64 vcc, 0
  s_cbranch_scc0 L_pok4
  s_mov_b32 s58, 20000
L_pl4:
  s_cmp_lt_u32 s58, 19992
  s_cselect_b32 s59, s58, 0
  s_bitcmp1_b32 s59, 0
  s_cselect_b32 s59, 1048576, 0
  s_add_u32 s59, s59, s88
  buffer_load_dwordx4 v[44:47], v41, s[24:27], s59 offen sc1
  s_waitcnt vmcnt(0)
  v_xor_b32 v52, s98, v45
  v_xor_b32 v53, s98, v47
  v_or_b32 v52, v52, v53
  v_cmp_ne_u32 vcc, 0, v52
  s_cmp_lg_u64 vcc, 0
  s_cbranch_scc0 L_pok4
  s_sub_u32 s58, s58, 1
  s_cmp_lg_u32 s58, 0
  s_cbranch_scc1 L_pl4
L_pok4:
  v_lshlrev_b32 v52, 16, v44
  v_and_b32 v53, 0xffff0000, v44
  v_lshlrev_b32 v54, 16, v46
  v_and_b32 v55, 0xffff0000, v46
  v_add_f32_dpp v52, v52, v52 quad_perm:[1,0,3,2] row_mask:0xf bank_mask:0xf
  v_add_f32_dpp v53, v53, v53 quad_perm:[1,0,3,2] row_mask:0xf bank_mask:0xf
  v_add_f32_dpp v54, v54, v54 quad_perm:[1,0,3,2] row_mask:0xf bank_mask:0xf
  v_add_f32_dpp v55, v55, v55 quad_perm:[1,0,3,2] row_mask:0xf bank_mask:0xf
  v_add_f32_dpp v52, v52, v52 quad_perm:[2,3,0,1] row_mask:0xf bank_mask:0xf
  v_add_f32_dpp v53, v53, v53 quad_perm:[2,3,0,1] row_mask:0xf bank_mask:0xf
  v_add_f32_dpp v54, v54, v54 quad_perm:[2,3,0,1] row_mask:0xf bank_mask:0xf
  v_add_f32_dpp v55, v55, v55 quad_perm:[2,3,0,1] row_mask:0xf bank_mask:0xf
  v_add_f32_dpp v52, v52, v52 row_half_mirror row_mask:0xf bank_mask:0xf
  v_add_f32_dpp v53, v53, v53 row_half_mirror row_mask:0xf bank_mask:0xf
  v_add_f32_dpp v54, v54, v54 row_half_mirror row_mask:0xf bank_mask:0xf
  v_add_f32_dpp v55, v55, v55 row_half_mirror row_mask:0xf bank_mask:0xf
  v_cvt_pk_bf16_f32 v52, v52, v52
  v_cvt_pk_bf16_f32 v53, v53, v53
  v_cvt_pk_bf16_f32 v54, v54, v54
  v_cvt_pk_bf16_f32 v55, v55, v55
  v_and_b32 v32, v4, v52
  v_and_b32 v33, v5, v52
  v_and_b32 v34, v6, v52
  v_and_b32 v35, v7, v52
  s_nop 1
  v_mfma_f32_16x16x32_bf16 v[8:11], v[32:35], v[192:195], 0
  v_and_b32 v36, v4, v53
  v_and_b32 v37, v5, v53
  v_and_b32 v38, v6, v53
  v_and_b32 v39, v7, v53
  s_nop 1
  v_mfma_f32_16x16x32_bf16 v[12:15], v[36:39], v[196:199], 0
  v_and_b32 v32, v4, v54
  v_and_b32 v33, v5, v54
  v_and_b32 v34, v6, v54
  v_and_b32 v35, v7, v54
  s_nop 1
  v_mfma_f32_16x16x32_bf16 v[8:11], v[32:35], v[200:203], v[8:11]
  v_and_b32 v36, v4, v55
  v_and_b32 v37, v5, v55
  v_and_b32 v38, v6, v55
  v_and_b32 v39, v7, v55
  s_nop 1
  v_mfma_f32_16x16x32_bf16 v[12:15], v[36:39], v[204:207], v[12:15]
  s_nop 7
  v_add_f32 v8, v8, v12
  v_add_f32 v9, v9, v13
  v_add_f32 v10, v10, v14
  v_add_f32 v11, v11, v15
  v_mov_b32 v32, v8
  v_mov_b32 v33, v9
  v_mov_b32 v34, v10
  v_mov_b32 v35, v11
  v_permlane32_swap_b32 v8, v32
  v_permlane32_swap_b32 v9, v33
  v_permlane32_swap_b32 v10, v34
  v_permlane32_swap_b32 v11, v35
  v_add_f32_dpp v8, v32, v8 row_ror:8 row_mask:0xf bank_mask:0xf
  v_add_f32_dpp v9, v33, v9 row_ror:8 row_mask:0xf bank_mask:0xf
  v_add_f32_dpp v10, v34, v10 row_ror:8 row_mask:0xf bank_mask:0xf
  v_add_f32_dpp v11, v35, v11 row_ror:8 row_mask:0xf bank_mask:0xf
  s_mov_b32 exec_lo, 0x00ff00ff
  s_mov_b32 exec_hi, 0
  ds_write_b128 v48, v[8:11] offset:4096
  s_mov_b64 exec, -1
  s_waitcnt lgkmcnt(0)
  s_barrier
  s_cmp_lg_u32 s97, 0
  s_cbranch_scc1 L_notO2
  ds_read_b32 v40, v49 offset:4096
  ds_read_b32 v41, v49 offset:4352
  ds_read_b32 v42, v49 offset:4608
  ds_read_b32 v43, v49 offset:4864
  ds_read_b32 v44, v49 offset:5120
  ds_read_b32 v45, v49 offset:5376
  ds_read_b32 v46, v49 offset:5632
  ds_read_b32 v47, v49 offset:5888
  s_lshl_b32 s3, s100, 12
  s_bfe_u32 s55, s101, 0x10003
  s_lshl_b32 s55, s55, 11
  s_add_u32 s3, s3, s55
  s_and_b32 s55, s101, 7
  s_lshl_b32 s55, s55, 8
  s_add_u32 s3, s3, s55
  s_add_u32 s3, s3, 196608
  s_waitcnt lgkmcnt(6)
  v_add_f32 v40, v40, v41
  s_waitcnt lgkmcnt(4)
  v_add_f32 v42, v42, v43
  v_add_f32 v40, v40, v42
  s_waitcnt lgkmcnt(2)
  v_add_f32 v44, v44, v45
  s_waitcnt lgkmcnt(0)
  v_add_f32 v46, v46, v47
  v_add_f32 v44, v44, v46
  v_add_f32 v40, v40, v44
  s_nop 1
  v_mov_b32_dpp v41, v40 quad_perm:[1,0,3,2] row_mask:0xf bank_mask:0xf
  v_cvt_pk_bf16_f32 v40, v40, v41
  v_mov_b32 v41, s98
  s_mov_b32 exec_lo, 0x55555555
  s_mov_b32 exec_hi, 0x55555555
  buffer_store_dwordx2 v[40:41], v49, s[24:27], s3 offen sc0 sc1
  s_mov_b64 exec, -1
L_notO2:
  s_branch L_fin
L_nowo:
  s_cmp_ge_u32 s52, 64
  s_cbranch_scc1 L_fin
  s_barrier
  s_cmp_eq_u32 s97, 0
  s_cbranch_scc1 L_late
  s_cmp_ge_u32 s97, 4
  s_cbranch_scc1 L_late
  s_branch L_issued
L_late:
  s_mov_b32 s85, 786432
  v_lshrrev_b32 v52, 3, v0
  s_lshl_b32 s3, s97, 6
  v_add_u32 v3, s3, v52
  v_mul_u32_u24 v3, 2752, v3
  v_and_b32 v53, 3, v0
  v_lshl_add_u32 v3, v53, 4, v3
  s_lshl_b32 s3, s52, 6
  v_add_u32 v3, s3, v3
  s_mov_b32 s89, 22016
  s_mov_b32 s90, 44032
  s_mov_b32 s91, 66048
  s_mov_b32 s92, 88064
  s_mov_b32 s93, 110080
  s_mov_b32 s94, 132096
  s_mov_b32 s95, 154112
  v_lshlrev_b32 v50, 12, v52
  v_and_b32 v53, 7, v0
  v_lshl_add_u32 v50, v53, 4, v50
  s_lshl_b32 s3, s52, 15
  s_lshl_b32 s55, s97, 7
  s_add_u32 s3, s3, s55
  v_add_u32 v50, s3, v50
  v_and_b32 v53, 15, v0
  v_lshrrev_b32 v52, 4, v0
  v_lshl_add_u32 v53, v53, 2, v52
  s_lshl_b32 s3, s97, 6
  v_add_u32 v193, s3, v53
  v_lshlrev_b32 v52, 1, v193
  v_mov_b32 v192, 0
  v_lshlrev_b32 v194, 4, v193
  buffer_load_dwordx4 v[184:187], v194, s[24:27], s85 offen sc1
  buffer_load_short_d16_hi v192, v52, s[40:43], 0 offen nt
  s_mov_b32 exec_lo, 0x0f0f0f0f
  s_mov_b32 exec_hi, 0x0f0f0f0f
  buffer_load_dwordx4 v[128:131], v3, s[28:31], 0 offen nt
  buffer_load_dwordx4 v[132:135], v3, s[28:31], s89 offen nt
  buffer_load_dwordx4 v[136:139], v3, s[28:31], s90 offen nt
  buffer_load_dwordx4 v[140:143], v3, s[28:31], s91 offen nt
  buffer_load_dwordx4 v[144:147], v3, s[28:31], s92 offen nt
  buffer_load_dwordx4 v[148:151], v3, s[28:31], s93 offen nt
  buffer_load_dwordx4 v[152:155], v3, s[28:31], s94 offen nt
  buffer_load_dwordx4 v[156:159], v3, s[28:31], s95 offen nt
  s_mov_b32 exec_lo, 0xf0f0f0f0
  s_mov_b32 exec_hi, 0xf0f0f0f0
  buffer_load_dwordx4 v[128:131], v3, s[32:35], 0 offen nt
  buffer_load_dwordx4 v[132:135], v3, s[32:35], s89 offen nt
  buffer_load_dwordx4 v[136:139], v3, s[32:35], s90 offen nt
  buffer_load_dwordx4 v[140:143], v3, s[32:35], s91 offen nt
  buffer_load_dwordx4 v[144:147], v3, s[32:35], s92 offen nt
  buffer_load_dwordx4 v[148:151], v3, s[32:35], s93 offen nt
  buffer_load_dwordx4 v[152:155], v3, s[32:35], s94 offen nt
  buffer_load_dwordx4 v[156:159], v3, s[32:35], s95 offen nt
  s_mov_b64 exec, -1
  buffer_load_dwordx4 v[160:163], v50, s[36:39], 0 offen offset:0 nt
  buffer_load_dwordx4 v[164:167], v50, s[36:39], 0 offen offset:1024 nt
  buffer_load_dwordx4 v[168:171], v50, s[36:39], 0 offen offset:2048 nt
  buffer_load_dwordx4 v[172:175], v50, s[36:39], 0 offen offset:3072 nt
L_issued:
  s_waitcnt vmcnt(4)
  v_xor_b32 v56, s98, v185
  v_xor_b32 v57, s98, v187
  v_or_b32 v56, v56, v57
  v_cmp_ne_u32 vcc, 0, v56
  s_cmp_lg_u64 vcc, 0
  s_cbranch_scc0 L_pok5
  s_mov_b32 s58, 20000
L_pl5:
  buffer_load_dwordx4 v[184:187], v194, s[24:27], s85 offen sc1
  s_waitcnt vmcnt(0)
  v_xor_b32 v56, s98, v185
  v_xor_b32 v57, s98, v187
  v_or_b32 v56, v56, v57
  v_cmp_ne_u32 vcc, 0, v56
  s_cmp_lg_u64 vcc, 0
  s_cbranch_scc0 L_pok5
  s_sub_u32 s58, s58, 1
  s_cmp_lg_u32 s58, 0
  s_cbranch_scc1 L_pl5
L_pok5:
  v_lshlrev_b32 v176, 16, v184
  v_and_b32 v178, 0xffff0000, v184
  v_lshlrev_b32 v180, 16, v186
  v_and_b32 v182, 0xffff0000, v186
  v_add_f32 v58, 1.0, v180
  v_cvt_pk_bf16_f32 v58, v58, v58
  v_and_b32 v58, 0xffff0000, v58
  s_mov_b32 s56, 0x00003f80
  s_mov_b32 s57, 0x3f800000
  s_lshl_b32 s3, s97, 3
  v_mov_b32 v17, s3
  v_and_b32 v18, 7, v0
  v_lshlrev_b32 v18, 3, v18
  v_lshrrev_b32 v19, 3, v0
  v_and_b32 v20, 3, v19
  v_lshlrev_b32 v20, 6, v20
  v_lshrrev_b32 v19, 2, v19
  v_lshl_add_u32 v19, v19, 2, v20
  s_barrier
  v_lshrrev_b32 v54, 4, v0
  v_lshlrev_b32 v54, 11, v54
  v_and_b32 v55, 15, v0
  v_lshl_add_u32 v54, v55, 4, v54
  s_lshl_b32 s87, s97, 8
  s_add_u32 s87, s87, 196608
  s_add_u32 s88, s87, 8192
  s_add_u32 s54, s87, 16384
  s_add_u32 s55, s87, 24576
  buffer_load_dwordx4 v[60:63], v54, s[24:27], s87 offen sc1
  buffer_load_dwordx4 v[64:67], v54, s[24:27], s88 offen sc1
  buffer_load_dwordx4 v[68:71], v54, s[24:27], s54 offen sc1
  buffer_load_dwordx4 v[72:75], v54, s[24:27], s55 offen sc1
  s_waitcnt vmcnt(0)
  v_min3_u32 v56, v61, v63, v65
  v_max3_u32 v57, v61, v63, v65
  v_min3_u32 v56, v56, v67, v69
  v_max3_u32 v57, v57, v67, v69
  v_min3_u32 v56, v56, v71, v73
  v_max3_u32 v57, v57, v71, v73
  v_min_u32 v56, v56, v75
  v_max_u32 v57, v57, v75
  v_xor_b32 v56, s98, v56
  v_xor_b32 v57, s98, v57
  v_or_b32 v56, v56, v57
  v_cmp_ne_u32 vcc, 0, v56
  s_cmp_lg_u64 vcc, 0
  s_cbranch_scc0 L_pok6
  s_mov_b32 s58, 20000
L_pl6:
  buffer_load_dwordx4 v[60:63], v54, s[24:27], s87 offen sc1
  buffer_load_dwordx4 v[64:67], v54, s[24:27], s88 offen sc1
  buffer_load_dwordx4 v[68:71], v54, s[24:27], s54 offen sc1
  buffer_load_dwordx4 v[72:75], v54, s[24:27], s55 offen sc1
  s_waitcnt vmcnt(0)
  v_min3_u32 v56, v61, v63, v65
  v_max3_u32 v57, v61, v63, v65
  v_min3_u32 v56, v56, v67, v69
  v_max3_u32 v57, v57, v67, v69
  v_min3_u32 v56, v56, v71, v73
  v_max3_u32 v57, v57, v71, v73
  v_min_u32 v56, v56, v75
  v_max_u32 v57, v57, v75
  v_xor_b32 v56, s98, v56
  v_xor_b32 v57, s98, v57
  v_or_b32 v56, v56, v57
  v_cmp_ne_u32 vcc, 0, v56
  s_cmp_lg_u64 vcc, 0
  s_cbranch_scc0 L_pok6
  s_sub_u32 s58, s58, 1
  s_cmp_lg_u32 s58, 0
  s_cbranch_scc1 L_pl6
L_pok6:
  v_dot2_f32_bf16 v24, v60, s56, 0
  v_dot2_f32_bf16 v25, v60, s57, 0
  v_dot2_f32_bf16 v26, v62, s56, 0
  v_dot2_f32_bf16 v27, v62, s57, 0
  v_dot2_f32_bf16 v24, v64, s56, v24
  v_dot2_f32_bf16 v25, v64, s57, v25
  v_dot2_f32_bf16 v26, v66, s56, v26
  v_dot2_f32_bf16 v27, v66, s57, v27
  v_dot2_f32_bf16 v24, v68, s56, v24
  v_dot2_f32_bf16 v25, v68, s57, v25
  v_dot2_f32_bf16 v26, v70, s56, v26
  v_dot2_f32_bf16 v27, v70, s57, v27
  v_dot2_f32_bf16 v24, v72, s56, v24
  v_dot2_f32_bf16 v25, v72, s57, v25
  v_dot2_f32_bf16 v26, v74, s56, v26
  v_dot2_f32_bf16 v27, v74, s57, v27
  s_nop 1
  v_permlane32_swap_b32 v24, v26
  v_permlane32_swap_b32 v25, v27
  v_add_f32 v24, v24, v26
  v_add_f32 v25, v25, v27
  s_nop 1
  v_permlane16_swap_b32 v24, v25
  v_add_f32 v24, v24, v25
  v_cvt_pk_bf16_f32 v24, v24, v24
  v_and_b32 v24, 0xffff0000, v24
  v_mul_f32 v24, v24, v176
  v_cvt_pk_bf16_f32 v24, v24, v24
  v_and_b32 v24, 0xffff0000, v24
  v_add_f32 v59, v24, v192
  v_cvt_pk_bf16_f32 v59, v59, v59
  v_and_b32 v59, 0xffff0000, v59
  v_mov_b32 v20, v59
  v_mul_f32 v21, v59, v59
  s_nop 0
  v_add_f32_dpp v20, v20, v20 row_ror:8 row_mask:0xf bank_mask:0xf
  v_add_f32_dpp v21, v21, v21 row_ror:8 row_mask:0xf bank_mask:0xf
  s_nop 0
  v_add_f32_dpp v20, v20, v20 row_ror:4 row_mask:0xf bank_mask:0xf
  v_add_f32_dpp v21, v21, v21 row_ror:4 row_mask:0xf bank_mask:0xf
  s_nop 0
  v_add_f32_dpp v20, v20, v20 row_ror:2 row_mask:0xf bank_mask:0xf
  v_add_f32_dpp v21, v21, v21 row_ror:2 row_mask:0xf bank_mask:0xf
  s_nop 0
  v_add_f32_dpp v20, v20, v20 row_ror:1 row_mask:0xf bank_mask:0xf
  v_add_f32_dpp v21, v21, v21 row_ror:1 row_mask:0xf bank_mask:0xf
  s_nop 0
  v_add_f32_dpp v20, v20, v20 row_bcast:15 row_mask:0xa bank_mask:0xf
  v_add_f32_dpp v21, v21, v21 row_bcast:15 row_mask:0xa bank_mask:0xf
  s_nop 0
  v_add_f32_dpp v20, v20, v20 row_bcast:31 row_mask:0xc bank_mask:0xf
  v_add_f32_dpp v21, v21, v21 row_bcast:31 row_mask:0xc bank_mask:0xf
  s_mov_b32 exec_lo, 0
  s_mov_b32 exec_hi, 0x80000000
  ds_write_b64 v17, v[20:21] offset:320
  s_mov_b64 exec, -1
  s_waitcnt lgkmcnt(0)
  s_barrier
  ds_read_b64 v[20:21], v18 offset:320
  v_mov_b32 v24, v59
  s_waitcnt lgkmcnt(0)
  v_add_f32_dpp v20, v20, v20 quad_perm:[1,0,3,2] row_mask:0xf bank_mask:0xf
  v_add_f32_dpp v21, v21, v21 quad_perm:[1,0,3,2] row_mask:0xf bank_mask:0xf
  s_nop 0
  v_add_f32_dpp v20, v20, v20 quad_perm:[2,3,0,1] row_mask:0xf bank_mask:0xf
  v_add_f32_dpp v21, v21, v21 quad_perm:[2,3,0,1] row_mask:0xf bank_mask:0xf
  s_nop 0
  v_add_f32_dpp v20, v20, v20 row_half_mirror row_mask:0xf bank_mask:0xf
  v_add_f32_dpp v21, v21, v21 row_half_mirror row_mask:0xf bank_mask:0xf
  v_mul_f32 v20, 0x3b000000, v20
  v_mul_f32 v21, 0x3b000000, v21
  v_fma_f32 v21, -v20, v20, v21
  v_cvt_pk_bf16_f32 v22, v20, v21
  v_lshlrev_b32 v20, 16, v22
  v_and_b32 v21, 0xffff0000, v22
  v_add_f32 v21, 0x3727c5ac, v21
  v_cvt_pk_bf16_f32 v21, v21, v21
  v_and_b32 v21, 0xffff0000, v21
  v_sqrt_f32 v21, v21
  s_nop 0
  v_cvt_pk_bf16_f32 v21, v21, v21
  v_and_b32 v21, 0xffff0000, v21
  v_rcp_f32 v21, v21
  v_sub_f32 v24, v24, v20
  v_cvt_pk_bf16_f32 v24, v24, v24
  v_and_b32 v24, 0xffff0000, v24
  v_mul_f32 v24, v24, v21
  v_cvt_pk_bf16_f32 v24, v24, v24
  v_and_b32 v24, 0xffff0000, v24
  v_mul_f32 v24, v24, v58
  v_cvt_pk_bf16_f32 v24, v24, v24
  v_and_b32 v24, 0xffff0000, v24
  v_add_f32 v24, v24, v178
  v_cvt_pk_bf16_f32 v24, v24, v24
  ds_bpermute_b32 v40, v19, v24 offset:0
  ds_bpermute_b32 v41, v19, v24 offset:8
  ds_bpermute_b32 v42, v19, v24 offset:16
  ds_bpermute_b32 v43, v19, v24 offset:24
  ds_bpermute_b32 v44, v19, v24 offset:32
  ds_bpermute_b32 v45, v19, v24 offset:40
  ds_bpermute_b32 v46, v19, v24 offset:48
  ds_bpermute_b32 v47, v19, v24 offset:56
  s_lshl_b32 s3, s97, 8
  v_add_u32 v48, s3, v2
  s_waitcnt lgkmcnt(7)
  v_and_b32 v32, v4, v40
  v_and_b32 v33, v5, v40
  v_and_b32 v34, v6, v40
  v_and_b32 v35, v7, v40
  s_nop 1
  v_mfma_f32_16x16x32_bf16 v[8:11], v[32:35], v[128:131], 0
  s_waitcnt lgkmcnt(6)
  v_and_b32 v36, v4, v41
  v_and_b32 v37, v5, v41
  v_and_b32 v38, v6, v41
  v_and_b32 v39, v7, v41
  s_nop 1
  v_mfma_f32_16x16x32_bf16 v[12:15], v[36:39], v[132:135], 0
  s_waitcnt lgkmcnt(5)
  v_and_b32 v32, v4, v42
  v_and_b32 v33, v5, v42
  v_and_b32 v34, v6, v42
  v_and_b32 v35, v7, v42
  s_nop 1
  v_mfma_f32_16x16x32_bf16 v[8:11], v[32:35], v[136:139], v[8:11]
  s_waitcnt lgkmcnt(4)
  v_and_b32 v36, v4, v43
  v_and_b32 v37, v5, v43
  v_and_b32 v38, v6, v43
  v_and_b32 v39, v7, v43
  s_nop 1
  v_mfma_f32_16x16x32_bf16 v[12:15], v[36:39], v[140:143], v[12:15]
  s_waitcnt lgkmcnt(3)
  v_and_b32 v32, v4, v44
  v_and_b32 v33, v5, v44
  v_and_b32 v34, v6, v44
  v_and_b32 v35, v7, v44
  s_nop 1
  v_mfma_f32_16x16x32_bf16 v[8:11], v[32:35], v[144:147], v[8:11]
  s_waitcnt lgkmcnt(2)
  v_and_b32 v36, v4, v45
  v_and_b32 v37, v5, v45
  v_and_b32 v38, v6, v45
  v_and_b32 v39, v7, v45
  s_nop 1
  v_mfma_f32_16x16x32_bf16 v[12:15], v[36:39], v[148:151], v[12:15]
  s_waitcnt lgkmcnt(1)
  v_and_b32 v32, v4, v46
  v_and_b32 v33, v5, v46
  v_and_b32 v34, v6, v46
  v_and_b32 v35, v7, v46
  s_nop 1
  v_mfma_f32_16x16x32_bf16 v[8:11], v[32:35], v[152:155], v[8:11]
  s_waitcnt lgkmcnt(0)
  v_and_b32 v36, v4, v47
  v_and_b32 v37, v5, v47
  v_and_b32 v38, v6, v47
  v_and_b32 v39, v7, v47
  s_nop 1
  v_mfma_f32_16x16x32_bf16 v[12:15], v[36:39], v[156:159], v[12:15]
  s_nop 7
  v_add_f32 v8, v8, v12
  v_add_f32 v9, v9, v13
  v_add_f32 v10, v10, v14
  v_add_f32 v11, v11, v15
  v_mov_b32 v32, v8
  v_mov_b32 v33, v9
  v_mov_b32 v34, v10
  v_mov_b32 v35, v11
  v_permlane32_swap_b32 v8, v32
  v_permlane32_swap_b32 v9, v33
  v_permlane32_swap_b32 v10, v34
  v_permlane32_swap_b32 v11, v35
  v_add_f32_dpp v8, v32, v8 row_ror:8 row_mask:0xf bank_mask:0xf
  v_add_f32_dpp v9, v33, v9 row_ror:8 row_mask:0xf bank_mask:0xf
  v_add_f32_dpp v10, v34, v10 row_ror:8 row_mask:0xf bank_mask:0xf
  v_add_f32_dpp v11, v35, v11 row_ror:8 row_mask:0xf bank_mask:0xf
  s_mov_b32 exec_lo, 0x00ff00ff
  s_mov_b32 exec_hi, 0
  ds_write_b128 v48, v[8:11] offset:6144
  s_mov_b64 exec, -1
  v_lshlrev_b32 v48, 2, v0
  v_lshrrev_b32 v1, 3, v0
  v_lshlrev_b32 v1, 4, v1
  s_waitcnt lgkmcnt(0)
  s_barrier
  ds_read_b32 v40, v48 offset:6144
  ds_read_b32 v41, v48 offset:6400
  ds_read_b32 v42, v48 offset:6656
  ds_read_b32 v43, v48 offset:6912
  ds_read_b32 v44, v48 offset:7168
  ds_read_b32 v45, v48 offset:7424
  ds_read_b32 v46, v48 offset:7680
  ds_read_b32 v47, v48 offset:7936
  s_waitcnt lgkmcnt(6)
  v_add_f32 v40, v40, v41
  s_waitcnt lgkmcnt(4)
  v_add_f32 v42, v42, v43
  v_add_f32 v40, v40, v42
  s_waitcnt lgkmcnt(2)
  v_add_f32 v44, v44, v45
  s_waitcnt lgkmcnt(0)
  v_add_f32 v46, v46, v47
  v_add_f32 v44, v44, v46
  v_add_f32 v40, v40, v44
  v_cvt_pk_bf16_f32 v40, v40, v40
  v_and_b32 v40, 0xffff0000, v40
  v_mov_b32 v41, v40
  s_nop 1
  v_permlane32_swap_b32 v40, v41
  v_mul_f32 v42, 0xbfb8aa3b, v40
  v_exp_f32 v42, v42
  s_nop 0
  v_add_f32 v42, 1.0, v42
  v_rcp_f32 v42, v42
  s_nop 0
  v_mul_f32 v40, v40, v42
  v_cvt_pk_bf16_f32 v40, v40, v40
  v_and_b32 v40, 0xffff0000, v40
  v_mul_f32 v40, v40, v41
  v_cvt_pk_bf16_f32 v40, v40, v40
  ds_bpermute_b32 v44, v1, v40 offset:0
  ds_bpermute_b32 v45, v1, v40 offset:4
  ds_bpermute_b32 v46, v1, v40 offset:8
  ds_bpermute_b32 v47, v1, v40 offset:12
  s_waitcnt vmcnt(0)
  s_lshl_b32 s3, s52, 11
  s_lshl_b32 s57, s97, 8
  s_add_u32 s3, s3, s57
  s_add_u32 s3, s3, 65536
  s_waitcnt lgkmcnt(3)
  v_and_b32 v32, v4, v44
  v_and_b32 v33, v5, v44
  v_and_b32 v34, v6, v44
  v_and_b32 v35, v7, v44
  s_nop 1
  v_mfma_f32_16x16x32_bf16 v[8:11], v[32:35], v[160:163], 0
  s_waitcnt lgkmcnt(2)
  v_and_b32 v36, v4, v45
  v_and_b32 v37, v5, v45
  v_and_b32 v38, v6, v45
  v_and_b32 v39, v7, v45
  s_nop 1
  v_mfma_f32_16x16x32_bf16 v[12:15], v[36:39], v[164:167], 0
  s_waitcnt lgkmcnt(1)
  v_and_b32 v32, v4, v46
  v_and_b32 v33, v5, v46
  v_and_b32 v34, v6, v46
  v_and_b32 v35, v7, v46
  s_nop 1
  v_mfma_f32_16x16x32_bf16 v[8:11], v[32:35], v[168:171], v[8:11]
  s_waitcnt lgkmcnt(0)
  v_and_b32 v36, v4, v47
  v_and_b32 v37, v5, v47
  v_and_b32 v38, v6, v47
  v_and_b32 v39, v7, v47
  s_nop 1
  v_mfma_f32_16x16x32_bf16 v[12:15], v[36:39], v[172:175], v[12:15]
  s_nop 7
  v_add_f32 v8, v8, v12
  v_add_f32 v9, v9, v13
  v_add_f32 v10, v10, v14
  v_add_f32 v11, v11, v15
  v_mov_b32 v32, v8
  v_mov_b32 v33, v9
  v_mov_b32 v34, v10
  v_mov_b32 v35, v11
  v_permlane32_swap_b32 v8, v32
  v_permlane32_swap_b32 v9, v33
  v_permlane32_swap_b32 v10, v34
  v_permlane32_swap_b32 v11, v35
  v_add_f32_dpp v8, v32, v8 row_ror:8 row_mask:0xf bank_mask:0xf
  v_add_f32_dpp v9, v33, v9 row_ror:8 row_mask:0xf bank_mask:0xf
  v_add_f32_dpp v10, v34, v10 row_ror:8 row_mask:0xf bank_mask:0xf
  v_add_f32_dpp v11, v35, v11 row_ror:8 row_mask:0xf bank_mask:0xf
  v_cvt_pk_bf16_f32 v32, v8, v9
  v_mov_b32 v33, s98
  v_cvt_pk_bf16_f32 v34, v10, v11
  v_mov_b32 v35, s98
  s_mov_b32 exec_lo, 0x00ff00ff
  s_mov_b32 exec_hi, 0
  buffer_store_dwordx4 v[32:35], v2, s[24:27], s3 offen sc0 sc1
  s_mov_b64 exec, -1
  s_cmp_ge_u32 s52, 16
  s_cbranch_scc1 L_fin
  v_lshlrev_b32 v3, 1, v193
  s_mov_b32 s56, 0x00010001
  s_lshr_b32 s3, s52, 1
  s_cmp_lg_u32 s97, s3
  s_cbranch_scc1 L_fin
  v_lshrrev_b32 v1, 3, v0
  v_lshlrev_b32 v1, 11, v1
  v_and_b32 v2, 7, v0
  v_lshl_add_u32 v1, v2, 4, v1
  s_lshl_b32 s78, s52, 7
  s_add_u32 s78, s78, 65536
  s_add_u32 s79, s78, 16384
  s_add_u32 s80, s78, 32768
  s_add_u32 s81, s78, 49152
  s_add_u32 s82, s78, 65536
  s_add_u32 s83, s78, 81920
  v_mov_b32 v84, 0
  v_mov_b32 v86, 0
  v_mov_b32 v85, s98
  v_mov_b32 v87, s98
  buffer_load_dwordx4 v[64:67], v1, s[24:27], s78 offen sc1
  buffer_load_dwordx4 v[68:71], v1, s[24:27], s79 offen sc1
  buffer_load_dwordx4 v[72:75], v1, s[24:27], s80 offen sc1
  buffer_load_dwordx4 v[76:79], v1, s[24:27], s81 offen sc1
  buffer_load_dwordx4 v[80:83], v1, s[24:27], s82 offen sc1
  s_mov_b32 exec_lo, 0xffffff
  s_mov_b32 exec_hi, 0
  buffer_load_dwordx4 v[84:87], v1, s[24:27], s83 offen sc1
  s_mov_b64 exec, -1
  s_mov_b32 s54, 0x00003f80
  s_mov_b32 s55, 0x3f800000
  s_bitcmp1_b32 s52, 0
  s_mov_b32 s56, 0x00ff00ff
  s_cselect_b32 s56, 0xff00ff00, s56
  s_waitcnt vmcnt(0)
  v_min3_u32 v120, v65, v67, v69
  v_max3_u32 v121, v65, v67, v69
  v_min3_u32 v120, v120, v71, v73
  v_max3_u32 v121, v121, v71, v73
  v_min3_u32 v120, v120, v75, v77
  v_max3_u32 v121, v121, v75, v77
  v_min3_u32 v120, v120, v79, v81
  v_max3_u32 v121, v121, v79, v81
  v_min3_u32 v120, v120, v83, v85
  v_max3_u32 v121, v121, v83, v85
  v_min_u32 v120, v120, v87
  v_max_u32 v121, v121, v87
  v_xor_b32 v120, s98, v120
  v_xor_b32 v121, s98, v121
  v_or_b32 v120, v120, v121
  v_cmp_ne_u32 vcc, 0, v120
  s_cmp_lg_u64 vcc, 0
  s_cbranch_scc0 L_pok7
  s_mov_b32 s58, 20000
L_pl7:
  buffer_load_dwordx4 v[64:67], v1, s[24:27], s78 offen sc1
  buffer_load_dwordx4 v[68:71], v1, s[24:27], s79 offen sc1
  buffer_load_dwordx4 v[72:75], v1, s[24:27], s80 offen sc1
  buffer_load_dwordx4 v[76:79], v1, s[24:27], s81 offen sc1
  buffer_load_dwordx4 v[80:83], v1, s[24:27], s82 offen sc1
  s_mov_b32 exec_lo, 0xffffff
  s_mov_b32 exec_hi, 0
  buffer_load_dwordx4 v[84:87], v1, s[24:27], s83 offen sc1
  s_mov_b64 exec, -1
  s_waitcnt vmcnt(0)
  v_min3_u32 v120, v65, v67, v69
  v_max3_u32 v121, v65, v67, v69
  v_min3_u32 v120, v120, v71, v73
  v_max3_u32 v121, v121, v71, v73
  v_min3_u32 v120, v120, v75, v77
  v_max3_u32 v121, v121, v75, v77
  v_min3_u32 v120, v120, v79, v81
  v_max3_u32 v121, v121, v79, v81
  v_min3_u32 v120, v120, v83, v85
  v_max3_u32 v121, v121, v83, v85
  v_min_u32 v120, v120, v87
  v_max_u32 v121, v121, v87
  v_xor_b32 v120, s98, v120
  v_xor_b32 v121, s98, v121
  v_or_b32 v120, v120, v121
  v_cmp_ne_u32 vcc, 0, v120
  s_cmp_lg_u64 vcc, 0
  s_cbranch_scc0 L_pok7
  s_sub_u32 s58, s58, 1
  s_cmp_lg_u32 s58, 0
  s_cbranch_scc1 L_pl7
L_pok7:
  v_dot2_f32_bf16 v112, v64, s54, 0
  v_dot2_f32_bf16 v113, v64, s55, 0
  v_dot2_f32_bf16 v114, v66, s54, 0
  v_dot2_f32_bf16 v115, v66, s55, 0
  v_dot2_f32_bf16 v112, v68, s54, v112
  v_dot2_f32_bf16 v113, v68, s55, v113
  v_dot2_f32_bf16 v114, v70, s54, v114
  v_dot2_f32_bf16 v115, v70, s55, v115
  v_dot2_f32_bf16 v112, v72, s54, v112
  v_dot2_f32_bf16 v113, v72, s55, v113
  v_dot2_f32_bf16 v114, v74, s54, v114
  v_dot2_f32_bf16 v115, v74, s55, v115
  v_dot2_f32_bf16 v112, v76, s54, v112
  v_dot2_f32_bf16 v113, v76, s55, v113
  v_dot2_f32_bf16 v114, v78, s54, v114
  v_dot2_f32_bf16 v115, v78, s55, v115
  v_dot2_f32_bf16 v112, v80, s54, v112
  v_dot2_f32_bf16 v113, v80, s55, v113
  v_dot2_f32_bf16 v114, v82, s54, v114
  v_dot2_f32_bf16 v115, v82, s55, v115
  v_dot2_f32_bf16 v112, v84, s54, v112
  v_dot2_f32_bf16 v113, v84, s55, v113
  v_dot2_f32_bf16 v114, v86, s54, v114
  v_dot2_f32_bf16 v115, v86, s55, v115
  s_nop 1
  v_permlane32_swap_b32 v112, v114
  v_permlane32_swap_b32 v113, v115
  v_add_f32 v112, v112, v114
  v_add_f32 v113, v113, v115
  s_nop 1
  v_permlane16_swap_b32 v112, v113
  v_add_f32 v112, v112, v113
  s_nop 1
  v_add_f32_dpp v112, v112, v112 row_ror:8 row_mask:0xf bank_mask:0xf
  v_cvt_pk_bf16_f32 v112, v112, v112
  v_and_b32 v112, 0xffff0000, v112
  v_mul_f32 v112, v112, v182
  v_cvt_pk_bf16_f32 v112, v112, v112
  v_and_b32 v112, 0xffff0000, v112
  v_add_f32 v112, v112, v59
  v_cvt_pk_bf16_f32 v116, v112, v112
  s_mov_b32 exec_lo, s56
  s_mov_b32 exec_hi, s56
  buffer_store_short v116, v3, s[48:51], 0 offen
  s_lshl_b32 s55, s52, 3
  s_add_u32 s55, s55, s97
  s_cmp_lg_u32 s55, 0
  s_cbranch_scc1 L_noep
  s_mov_b32 exec_lo, 1
  s_mov_b32 exec_hi, 0
  v_mov_b32 v118, s99
  v_mov_b32 v119, 0
  buffer_store_dword v118, v119, s[24:27], 0 offen sc0 sc1
L_noep:
  s_mov_b64 exec, -1
L_fin:
L_end:
  s_endpgm
.section .rodata,"a"
.p2align 6
.amdhsa_kernel adaLN_cond__gqa_block_cached__swiglu_ffn__decode_kernel
  .amdhsa_next_free_vgpr 256
  .amdhsa_next_free_sgpr 102
  .amdhsa_accum_offset 256
  .amdhsa_group_segment_fixed_size 0
  .amdhsa_kernarg_size 112
  .amdhsa_user_sgpr_count 2
  .amdhsa_user_sgpr_kernarg_segment_ptr 1
  .amdhsa_system_sgpr_workgroup_id_x 1
.end_amdhsa_kernel
```
